```python
import torch

def _softmax(x, axis=-1):
    return torch.softmax(x, dim=axis)
def _gelu(x):
    return torch.nn.functional.gelu(x, approximate="tanh")
def _silu(x):
    return torch.nn.functional.silu(x)
def _sigmoid(x):
    return torch.sigmoid(x)
def _layernorm(x, axis=-1, eps=1e-5):
    m = x.mean(dim=axis, keepdim=True)
    v = x.var(dim=axis, keepdim=True, unbiased=False)
    return (x - m) / torch.sqrt(v + eps)
def _scatter_add(tgt, idx, src, axis=0):
    return tgt.clone().index_add_(axis, idx, src)
def _segment_sum(src, seg, n):
    out = torch.zeros((n,) + src.shape[1:], dtype=src.dtype)
    return out.index_add_(0, seg, src)
def _pad(x, pw):
    flat = tuple(v for pair in reversed(pw) for v in pair)
    return torch.nn.functional.pad(x, flat)

kernel_name = 'gated_mix__sliding_block__spectral_fnet__prompt'

def setup_inputs():

    _w = (lambda a: (lambda t: t.to(torch.bfloat16) if t.is_floating_point() else t)(torch.as_tensor(a)))
    def _A_setup():
        B, S, D = 1, 2048, 512
        return {
            "x": _w((lambda *s: torch.randn(*s, dtype=torch.bfloat16) * 0.05)(B, S, D)),
            "wqkv": _w((lambda *s: torch.randn(*s, dtype=torch.bfloat16) * 1.6)(D, 3 * D)),
            "wo": _w((lambda *s: torch.randn(*s, dtype=torch.bfloat16) * 1.6)(D, D)),
        }
    _A_in = _A_setup()

    def _B_setup():
        B, S, D = 1, 2048, 512
        ns = torch.arange(S)[:, None] * torch.arange(S)[None, :]
        nd = torch.arange(D)[:, None] * torch.arange(D)[None, :]
        Ws_re = torch.cos(-2.0 * torch.pi * ns / S).to(float)
        Ws_im = torch.sin(-2.0 * torch.pi * ns / S).to(float)
        Wd_re = torch.cos(-2.0 * torch.pi * nd / D).to(float)
        Wd_im = torch.sin(-2.0 * torch.pi * nd / D).to(float)
        return {
            "x": _w((lambda *s: torch.randn(*s, dtype=torch.bfloat16) * 0.05)(B, S, D)),
            "dft_seq_re": _w(Ws_re),
            "dft_seq_im": _w(Ws_im),
            "dft_hid_re": _w(Wd_re),
            "dft_hid_im": _w(Wd_im),
        }
    _B_in = _B_setup()

    return {
        "A_x": _A_in["x"],
        "A_wqkv": _A_in["wqkv"],
        "A_wo": _A_in["wo"],
        "B_x": _B_in["x"],
        "B_dft_seq_re": _B_in["dft_seq_re"],
        "B_dft_seq_im": _B_in["dft_seq_im"],
        "B_dft_hid_re": _B_in["dft_hid_re"],
        "B_dft_hid_im": _B_in["dft_hid_im"],
        "gate_w": _w((lambda *s: torch.randn(*s, dtype=torch.bfloat16) * 0.05)(512) * 16.0),
    }

def reference(A_x, A_wqkv, A_wo, B_x, B_dft_seq_re, B_dft_seq_im, B_dft_hid_re, B_dft_hid_im, gate_w):
    def _A_ref(x, wqkv, wo):
        B, S, D = x.shape
        H = 32; Dh = D // H; W = 256
        qkv = (lambda x, *d: x.permute(*d))((x @ wqkv).reshape(B, S, 3, H, Dh), 2, 0, 3, 1, 4)
        q, k, v = qkv[0], qkv[1], qkv[2]
        scores = torch.einsum("bhqd,bhkd->bhqk", q, k) * (Dh ** -0.5)
        idx = torch.arange(S)
        mask = (idx[:, None] - idx[None, :] >= 0) & (idx[:, None] - idx[None, :] < W)
        scores = torch.where(mask[None, None], scores, -1e9)
        p = _softmax(scores, axis=-1)
        o = torch.einsum("bhqk,bhkd->bhqd", p, v)
        return (lambda x, *d: x.permute(*d))(o, 0, 2, 1, 3).reshape(B, S, D) @ wo

    def _B_ref(x, dft_seq_re, dft_seq_im, dft_hid_re, dft_hid_im):
        a = torch.einsum("bsd,ed->bse", x, dft_hid_re)
        b = torch.einsum("bsd,ed->bse", x, dft_hid_im)
        y = torch.einsum("ts,bse->bte", dft_seq_re, a) - torch.einsum("ts,bse->bte", dft_seq_im, b)
        return y

    x = A_x
    g = _sigmoid((x * gate_w).sum(-1, keepdims=True))
    a = _A_ref(x, A_wqkv, A_wo)
    b = _B_ref(x, B_dft_seq_re, B_dft_seq_im, B_dft_hid_re, B_dft_hid_im)
    return g * a + (1 - g) * b
```

```asm
; @launch grid=(256,1,1) block=(512,1,1) lds=163840
.amdgcn_target "amdgcn-amd-amdhsa--gfx950"
.text
.globl gated_mix__sliding_block__spectral_fnet__prompt_kernel
.p2align 8
.type gated_mix__sliding_block__spectral_fnet__prompt_kernel,@function
gated_mix__sliding_block__spectral_fnet__prompt_kernel:
    s_cmp_ge_u32 s2, 256
    s_cbranch_scc1 L_end
    s_load_dwordx16 s[4:19], s[0:1], 0
    s_load_dwordx8 s[20:27], s[0:1], 64
    s_getpc_b64 s[60:61]
    s_lshr_b32 s50, s2, 3
    v_and_b32 v1, 63, v0
    s_min_u32 s62, s50, 21
    v_lshlrev_b32 v2, 4, v1
    s_lshl_b32 s62, s62, 10
    v_add_u32 v3, s62, v2
    global_load_dwordx4 v[252:255], v3, s[60:61]
    v_lshrrev_b32 v3, 6, v0
    s_nop 0
    v_readfirstlane_b32 s48, v3
    s_and_b32 s49, s2, 7
    s_and_b32 s51, s50, 15
    s_lshr_b32 s53, s50, 4
    s_and_b32 s54, s48, 3
    s_cmp_lt_u32 s48, 4
    s_cbranch_scc1 L_compute
    v_and_b32 v6, 7, v1
    v_lshrrev_b32 v7, 4, v1
    v_xor_b32 v6, v6, v7
    v_lshlrev_b32 v6, 4, v6
    v_xor_b32 v7, 64, v6
    v_lshrrev_b32 v8, 3, v1
    s_lshl_b32 s99, s54, 12
    s_lshl_b32 s59, s51, 2
    s_add_u32 s59, s59, s54
    s_lshl_b32 s60, s59, 5
    s_cmp_eq_u32 s53, 1
    s_cselect_b32 s59, s59, s60
    s_cselect_b32 s60, 6, 0
    s_lshl_b32 s61, 0x2000, s60
    s_sub_u32 s61, s61, 1024
    v_lshlrev_b32 v9, s60, v8
    v_add_lshl_u32 v9, v9, s59, 10
    v_add_u32 v10, v9, v6
    v_add3_u32 v11, v9, v7, s61
    s_lshl_b32 s61, s61, 1
    v_add_u32 v12, s61, v10
    v_add_u32 v13, s61, v11
    s_lshl_b32 s97, s49, 7
    s_mov_b32 m0, s99
    s_mov_b32 s38, 0x200000
    s_mov_b32 s39, 0x20000
    s_waitcnt lgkmcnt(0)
    s_mov_b32 s36, s4
    s_mov_b32 s37, s5
    buffer_load_dwordx4 v10, s[36:39], s97 offen offset:0 lds
    buffer_load_dwordx4 v11, s[36:39], s97 offen offset:1024 lds
    buffer_load_dwordx4 v12, s[36:39], s97 offen offset:2048 lds
    buffer_load_dwordx4 v13, s[36:39], s97 offen offset:3072 lds
    s_and_b32 s56, s50, 7
    s_lshr_b32 s59, s50, 3
    s_lshl_b32 s55, s49, 2
    s_add_u32 s55, s55, s59
    v_and_b32 v4, 31, v1
    v_lshrrev_b32 v5, 5, v1
    v_bfe_u32 v20, v1, 2, 3
    v_mul_u32_u24 v20, 3072, v20
    v_lshl_add_u32 v20, v5, 6, v20
    v_and_b32 v21, 3, v1
    v_lshl_add_u32 v20, v21, 4, v20
    v_add_u32 v20, s97, v20
    s_mov_b32 s32, s6
    s_mov_b32 s33, s7
    s_mov_b32 s34, 0x180000
    s_mov_b32 s35, 0x20000
    s_and_b32 s60, s54, 1
    s_cmp_eq_u32 s53, 1
    s_cbranch_scc1 L_lz
    s_lshr_b32 s59, s54, 1
    s_lshl_b32 s59, s59, 10
    s_mul_i32 s60, s60, 98304
    s_add_u32 s59, s59, s60
    s_add_u32 s59, s59, 1024
    v_add_u32 v14, s59, v20
    v_add_u32 v15, 23552, v14
    v_add_u32 v16, 49152, v14
    v_mov_b32 v18, v14
    s_mov_b32 s40, s6
    s_mov_b32 s41, s7
    s_mov_b32 s42, 0x180000
    s_mov_b32 s43, 0x20000
    s_mov_b32 s44, s6
    s_mov_b32 s45, s7
    s_mov_b32 s46, 0x180000
    s_mov_b32 s47, 0x20000
    s_add_u32 s100, s99, 16384
    s_add_u32 s57, s99, 18432
    s_branch L_lgo
L_lz:
    s_lshl_b32 s59, s49, 5
    s_lshl_b32 s60, s60, 4
    s_add_u32 s59, s59, s60
    v_add_lshl_u32 v9, v8, s59, 10
    v_add_u32 v14, v9, v6
    v_add_u32 v15, v9, v7
    v_add_u32 v15, 7168, v15
    s_mul_i32 s59, s54, 49152
    v_add_u32 v16, s59, v20
    s_lshl_b32 s100, s54, 11
    s_add_u32 s57, s100, 24576
    s_add_u32 s100, s100, 16384
    s_cmp_ge_u32 s54, 2
    s_cselect_b32 s40, s18, s16
    s_cselect_b32 s41, s19, s17
    s_mov_b32 s42, 0x80000
    s_mov_b32 s43, 0x20000
    s_lshl_b32 s59, s49, 2
    s_add_u32 s59, s59, s54
    s_cmp_eq_u32 s59, 2
    s_cselect_b32 s60, 262144, 0
    s_cselect_b32 s44, s16, s40
    s_cselect_b32 s45, s17, s41
    s_mov_b32 s46, 0x80000
    s_mov_b32 s47, 0x20000
    v_add_u32 v18, s60, v14
L_lgo:
    v_add_u32 v17, 23552, v16
    s_add_u32 s97, s49, 0
    s_and_b32 s97, s97, 7
    s_mul_i32 s98, s97, 196608
    s_lshl_b32 s97, s97, 7
    s_add_u32 m0, s100, 0
    s_cmp_eq_u32 s53, 1
    s_cselect_b32 s58, s97, s98
    s_mov_b64 exec, 0xff
    buffer_load_dwordx4 v18, s[44:47], s58 offen lds
    s_not_b64 exec, exec
    buffer_load_dwordx4 v14, s[40:43], s58 offen lds
    s_mov_b64 exec, -1
    buffer_load_dwordx4 v15, s[40:43], s58 offen offset:1024 lds
    s_add_u32 m0, s57, 0
    s_nop 0
    buffer_load_dwordx4 v16, s[32:35], s98 offen lds
    buffer_load_dwordx4 v17, s[32:35], s98 offen offset:1024 lds
    s_lshl_b32 s52, s2, 3
    s_lshl_b32 s59, s54, 1
    s_add_u32 s52, s52, s59
    s_lshl_b32 s59, s52, 10
    s_mov_b32 s28, s20
    s_mov_b32 s29, s21
    s_mov_b32 s30, 0x400
    s_mov_b32 s31, 0x20000
    buffer_load_dwordx4 v[32:35], v2, s[36:39], s59 offen
    buffer_load_dwordx4 v[36:39], v2, s[36:39], s59 offen offset:1024
    buffer_load_dwordx4 v[40:43], v2, s[28:31], 0 offen
    v_lshlrev_b32 v231, 2, v5
    v_sub_u32 v231, v4, v231
    v_cmp_le_i32 s[64:65], 0, v231
    v_cmp_le_i32 s[66:67], 1, v231
    v_cmp_le_i32 s[68:69], 2, v231
    v_cmp_le_i32 s[70:71], 3, v231
    v_cmp_le_i32 s[72:73], 8, v231
    v_cmp_le_i32 s[74:75], 9, v231
    v_cmp_le_i32 s[76:77], 10, v231
    v_cmp_le_i32 s[78:79], 11, v231
    v_cmp_le_i32 s[80:81], 16, v231
    v_cmp_le_i32 s[82:83], 17, v231
    v_cmp_le_i32 s[84:85], 18, v231
    v_cmp_le_i32 s[86:87], 19, v231
    v_cmp_le_i32 s[88:89], 24, v231
    v_cmp_le_i32 s[90:91], 25, v231
    v_cmp_le_i32 s[92:93], 26, v231
    v_cmp_le_i32 s[94:95], 27, v231
    v_mov_b32 v231, 0xffff
    v_mov_b32 v232, 0xffff0000
    v_cndmask_b32 v236, 0, v231, s[64:65]
    v_cndmask_b32 v52, 0, v232, s[66:67]
    v_cndmask_b32 v237, 0, v231, s[68:69]
    v_cndmask_b32 v53, 0, v232, s[70:71]
    v_cndmask_b32 v238, 0, v231, s[72:73]
    v_cndmask_b32 v54, 0, v232, s[74:75]
    v_cndmask_b32 v239, 0, v231, s[76:77]
    v_cndmask_b32 v55, 0, v232, s[78:79]
    v_cndmask_b32 v240, 0, v231, s[80:81]
    v_cndmask_b32 v56, 0, v232, s[82:83]
    v_cndmask_b32 v241, 0, v231, s[84:85]
    v_cndmask_b32 v57, 0, v232, s[86:87]
    v_cndmask_b32 v242, 0, v231, s[88:89]
    v_cndmask_b32 v58, 0, v232, s[90:91]
    v_cndmask_b32 v243, 0, v231, s[92:93]
    v_cndmask_b32 v59, 0, v232, s[94:95]
    v_or_b32 v236, v236, v52
    v_or_b32 v237, v237, v53
    v_or_b32 v238, v238, v54
    v_or_b32 v239, v239, v55
    v_or_b32 v240, v240, v56
    v_or_b32 v241, v241, v57
    v_or_b32 v242, v242, v58
    v_or_b32 v243, v243, v59
    v_mov_b32 v204, 0xf149f2ca
    v_mov_b32 v205, 0xf149f2ca
    v_mov_b32 v206, 0xf149f2ca
    v_mov_b32 v207, 0xf149f2ca
    v_mov_b32 v208, 0xf149f2ca
    v_mov_b32 v209, 0xf149f2ca
    v_mov_b32 v210, 0xf149f2ca
    v_mov_b32 v211, 0xf149f2ca
    v_mov_b32 v212, 0xf149f2ca
    v_mov_b32 v213, 0xf149f2ca
    v_mov_b32 v214, 0xf149f2ca
    v_mov_b32 v215, 0xf149f2ca
    v_mov_b32 v216, 0xf149f2ca
    v_mov_b32 v217, 0xf149f2ca
    v_mov_b32 v218, 0xf149f2ca
    v_mov_b32 v219, 0xf149f2ca
    s_lshl_b32 s62, s56, 3
    s_add_u32 s62, s62, s48
    s_add_u32 s4, s62, s48
    s_sub_i32 s4, s4, 8
    s_max_i32 s4, s4, 0
    s_lshl_b32 s63, s55, 6
    s_add_u32 s4, s4, s63
    s_lshl_b32 s4, s4, 10
    s_add_u32 s4, s4, 2097152
    s_add_u32 s5, s4, 2097152
    s_lshl_b32 s6, s55, 16
    s_lshl_b32 s63, s48, 13
    s_add_u32 s6, s6, s63
    s_lshl_b32 s63, s56, 6
    s_add_u32 s6, s6, s63
    v_lshrrev_b32 v222, 2, v1
    v_lshlrev_b32 v222, 9, v222
    v_and_b32 v231, 3, v1
    v_lshl_add_u32 v222, v231, 4, v222
    v_lshlrev_b32 v233, 11, v231
    v_bfe_u32 v231, v1, 2, 1
    v_lshl_add_u32 v233, v231, 9, v233
    v_lshrrev_b32 v231, 3, v1
    v_lshl_add_u32 v233, v231, 4, v233
    s_lshr_b32 s63, s48, 2
    s_lshl_b32 s63, s63, 10
    s_lshl_b32 s62, s54, 7
    s_add_u32 s63, s63, s62
    s_add_u32 s63, s63, 106496
    v_add_u32 v233, s63, v233
    s_add_u32 m0, s99, 32768
    s_add_u32 s97, s49, 1
    s_and_b32 s97, s97, 7
    s_mul_i32 s98, s97, 196608
    s_lshl_b32 s97, s97, 7
    buffer_load_dwordx4 v10, s[36:39], s97 offen offset:0 lds
    buffer_load_dwordx4 v11, s[36:39], s97 offen offset:1024 lds
    buffer_load_dwordx4 v12, s[36:39], s97 offen offset:2048 lds
    buffer_load_dwordx4 v13, s[36:39], s97 offen offset:3072 lds
    s_add_u32 m0, s100, 32768
    s_cmp_eq_u32 s53, 1
    s_cselect_b32 s58, s97, s98
    s_mov_b64 exec, 0xff
    buffer_load_dwordx4 v18, s[44:47], s58 offen lds
    s_not_b64 exec, exec
    buffer_load_dwordx4 v14, s[40:43], s58 offen lds
    s_mov_b64 exec, -1
    buffer_load_dwordx4 v15, s[40:43], s58 offen offset:1024 lds
    s_add_u32 m0, s57, 32768
    s_nop 0
    buffer_load_dwordx4 v16, s[32:35], s98 offen lds
    buffer_load_dwordx4 v17, s[32:35], s98 offen offset:1024 lds
    s_add_u32 m0, s99, 65536
    s_add_u32 s97, s49, 2
    s_and_b32 s97, s97, 7
    s_mul_i32 s98, s97, 196608
    s_lshl_b32 s97, s97, 7
    buffer_load_dwordx4 v10, s[36:39], s97 offen offset:0 lds
    buffer_load_dwordx4 v11, s[36:39], s97 offen offset:1024 lds
    buffer_load_dwordx4 v12, s[36:39], s97 offen offset:2048 lds
    buffer_load_dwordx4 v13, s[36:39], s97 offen offset:3072 lds
    s_add_u32 m0, s100, 65536
    s_cmp_eq_u32 s53, 1
    s_cselect_b32 s58, s97, s98
    s_mov_b64 exec, 0xff
    buffer_load_dwordx4 v18, s[44:47], s58 offen lds
    s_not_b64 exec, exec
    buffer_load_dwordx4 v14, s[40:43], s58 offen lds
    s_mov_b64 exec, -1
    buffer_load_dwordx4 v15, s[40:43], s58 offen offset:1024 lds
    s_add_u32 m0, s57, 65536
    s_nop 0
    buffer_load_dwordx4 v16, s[32:35], s98 offen lds
    buffer_load_dwordx4 v17, s[32:35], s98 offen offset:1024 lds
    s_mov_b32 s28, s26
    s_mov_b32 s29, s27
    s_mov_b32 s30, 0xd10000
    s_mov_b32 s31, 0x20000
    s_waitcnt vmcnt(18)
    v_lshlrev_b32 v44, 16, v40
    v_and_b32 v45, 0xffff0000, v40
    v_lshlrev_b32 v46, 16, v41
    v_and_b32 v47, 0xffff0000, v41
    v_lshlrev_b32 v48, 16, v42
    v_and_b32 v49, 0xffff0000, v42
    v_lshlrev_b32 v50, 16, v43
    v_and_b32 v51, 0xffff0000, v43
    v_lshlrev_b32 v64, 16, v32
    v_and_b32 v65, 0xffff0000, v32
    v_lshlrev_b32 v66, 16, v33
    v_and_b32 v67, 0xffff0000, v33
    v_lshlrev_b32 v68, 16, v34
    v_and_b32 v69, 0xffff0000, v34
    v_lshlrev_b32 v70, 16, v35
    v_and_b32 v71, 0xffff0000, v35
    v_mul_f32 v64, v64, v44
    v_mul_f32 v65, v65, v45
    v_mul_f32 v66, v66, v46
    v_mul_f32 v67, v67, v47
    v_mul_f32 v68, v68, v48
    v_mul_f32 v69, v69, v49
    v_mul_f32 v70, v70, v50
    v_mul_f32 v71, v71, v51
    v_cvt_pk_bf16_f32 v32, v64, v65
    v_cvt_pk_bf16_f32 v33, v66, v67
    v_cvt_pk_bf16_f32 v34, v68, v69
    v_cvt_pk_bf16_f32 v35, v70, v71
    v_lshlrev_b32 v64, 16, v32
    v_and_b32 v65, 0xffff0000, v32
    v_lshlrev_b32 v66, 16, v33
    v_and_b32 v67, 0xffff0000, v33
    v_lshlrev_b32 v68, 16, v34
    v_and_b32 v69, 0xffff0000, v34
    v_lshlrev_b32 v70, 16, v35
    v_and_b32 v71, 0xffff0000, v35
    v_add_f32 v64, v64, v68
    v_add_f32 v65, v65, v69
    v_add_f32 v66, v66, v70
    v_add_f32 v67, v67, v71
    v_add_f32 v64, v64, v66
    v_add_f32 v65, v65, v67
    v_add_f32 v64, v64, v65
    v_lshlrev_b32 v72, 16, v36
    v_and_b32 v73, 0xffff0000, v36
    v_lshlrev_b32 v74, 16, v37
    v_and_b32 v75, 0xffff0000, v37
    v_lshlrev_b32 v76, 16, v38
    v_and_b32 v77, 0xffff0000, v38
    v_lshlrev_b32 v78, 16, v39
    v_and_b32 v79, 0xffff0000, v39
    v_mul_f32 v72, v72, v44
    v_mul_f32 v73, v73, v45
    v_mul_f32 v74, v74, v46
    v_mul_f32 v75, v75, v47
    v_mul_f32 v76, v76, v48
    v_mul_f32 v77, v77, v49
    v_mul_f32 v78, v78, v50
    v_mul_f32 v79, v79, v51
    v_cvt_pk_bf16_f32 v36, v72, v73
    v_cvt_pk_bf16_f32 v37, v74, v75
    v_cvt_pk_bf16_f32 v38, v76, v77
    v_cvt_pk_bf16_f32 v39, v78, v79
    v_lshlrev_b32 v72, 16, v36
    v_and_b32 v73, 0xffff0000, v36
    v_lshlrev_b32 v74, 16, v37
    v_and_b32 v75, 0xffff0000, v37
    v_lshlrev_b32 v76, 16, v38
    v_and_b32 v77, 0xffff0000, v38
    v_lshlrev_b32 v78, 16, v39
    v_and_b32 v79, 0xffff0000, v39
    v_add_f32 v72, v72, v76
    v_add_f32 v73, v73, v77
    v_add_f32 v74, v74, v78
    v_add_f32 v75, v75, v79
    v_add_f32 v72, v72, v74
    v_add_f32 v73, v73, v75
    v_add_f32 v72, v72, v73
    v_add_f32_dpp v64, v64, v64 row_shr:1 row_mask:0xf bank_mask:0xf bound_ctrl:0
    s_nop 0
    v_add_f32_dpp v72, v72, v72 row_shr:1 row_mask:0xf bank_mask:0xf bound_ctrl:0
    v_add_f32_dpp v64, v64, v64 row_shr:2 row_mask:0xf bank_mask:0xf bound_ctrl:0
    s_nop 0
    v_add_f32_dpp v72, v72, v72 row_shr:2 row_mask:0xf bank_mask:0xf bound_ctrl:0
    v_add_f32_dpp v64, v64, v64 row_shr:4 row_mask:0xf bank_mask:0xf bound_ctrl:0
    s_nop 0
    v_add_f32_dpp v72, v72, v72 row_shr:4 row_mask:0xf bank_mask:0xf bound_ctrl:0
    v_add_f32_dpp v64, v64, v64 row_shr:8 row_mask:0xf bank_mask:0xf bound_ctrl:0
    s_nop 0
    v_add_f32_dpp v72, v72, v72 row_shr:8 row_mask:0xf bank_mask:0xf bound_ctrl:0
    v_add_f32_dpp v64, v64, v64 row_bcast:15 row_mask:0xa bank_mask:0xf
    s_nop 0
    v_add_f32_dpp v72, v72, v72 row_bcast:15 row_mask:0xa bank_mask:0xf
    v_add_f32_dpp v64, v64, v64 row_bcast:31 row_mask:0xc bank_mask:0xf
    s_nop 0
    v_add_f32_dpp v72, v72, v72 row_bcast:31 row_mask:0xc bank_mask:0xf
    v_readlane_b32 s59, v64, 63
    v_readlane_b32 s60, v72, 63
    s_nop 0
    v_mov_b32 v44, s59
    s_nop 1
    v_writelane_b32 v44, s60, 1
    v_cvt_pk_bf16_f32 v44, v44, v44
    v_lshlrev_b32 v44, 16, v44
    v_mul_f32 v44, 0xbfb8aa3b, v44
    v_exp_f32 v44, v44
    s_nop 0
    v_add_f32 v44, 1.0, v44
    v_rcp_f32 v44, v44
    s_nop 0
    v_cvt_pk_bf16_f32 v44, v44, v44
    v_lshlrev_b32 v44, 16, v44
    v_sub_f32 v45, 1.0, v44
    v_cvt_pk_bf16_f32 v45, v45, v45
    v_lshlrev_b32 v45, 16, v45
    v_lshlrev_b32 v46, 3, v1
    s_lshl_b32 s59, s52, 3
    s_add_u32 s59, s59, 12582912
    s_mov_b64 exec, 3
    buffer_store_dwordx2 v[44:45], v46, s[28:31], s59 offen sc1
    s_mov_b64 exec, -1
    s_barrier
    s_add_u32 m0, s99, 98304
    s_add_u32 s97, s49, 3
    s_and_b32 s97, s97, 7
    s_mul_i32 s98, s97, 196608
    s_lshl_b32 s97, s97, 7
    buffer_load_dwordx4 v10, s[36:39], s97 offen offset:0 lds
    buffer_load_dwordx4 v11, s[36:39], s97 offen offset:1024 lds
    buffer_load_dwordx4 v12, s[36:39], s97 offen offset:2048 lds
    buffer_load_dwordx4 v13, s[36:39], s97 offen offset:3072 lds
    s_add_u32 m0, s100, 98304
    s_cmp_eq_u32 s53, 1
    s_cselect_b32 s58, s97, s98
    s_mov_b64 exec, 0xff
    buffer_load_dwordx4 v18, s[44:47], s58 offen lds
    s_not_b64 exec, exec
    buffer_load_dwordx4 v14, s[40:43], s58 offen lds
    s_mov_b64 exec, -1
    buffer_load_dwordx4 v15, s[40:43], s58 offen offset:1024 lds
    s_add_u32 m0, s57, 98304
    s_nop 0
    buffer_load_dwordx4 v16, s[32:35], s98 offen lds
    buffer_load_dwordx4 v17, s[32:35], s98 offen offset:1024 lds
    s_waitcnt vmcnt(19)
    s_barrier
    s_add_u32 m0, s99, 0
    s_add_u32 s97, s49, 4
    s_and_b32 s97, s97, 7
    s_mul_i32 s98, s97, 196608
    s_lshl_b32 s97, s97, 7
    buffer_load_dwordx4 v10, s[36:39], s97 offen offset:0 lds
    buffer_load_dwordx4 v11, s[36:39], s97 offen offset:1024 lds
    buffer_load_dwordx4 v12, s[36:39], s97 offen offset:2048 lds
    buffer_load_dwordx4 v13, s[36:39], s97 offen offset:3072 lds
    s_add_u32 m0, s100, 0
    s_cmp_eq_u32 s53, 1
    s_cselect_b32 s58, s97, s98
    s_mov_b64 exec, 0xff
    buffer_load_dwordx4 v18, s[44:47], s58 offen lds
    s_not_b64 exec, exec
    buffer_load_dwordx4 v14, s[40:43], s58 offen lds
    s_mov_b64 exec, -1
    buffer_load_dwordx4 v15, s[40:43], s58 offen offset:1024 lds
    s_add_u32 m0, s57, 0
    s_nop 0
    buffer_load_dwordx4 v16, s[32:35], s98 offen lds
    buffer_load_dwordx4 v17, s[32:35], s98 offen offset:1024 lds
    s_waitcnt vmcnt(19)
    s_barrier
    s_add_u32 m0, s99, 32768
    s_add_u32 s97, s49, 5
    s_and_b32 s97, s97, 7
    s_mul_i32 s98, s97, 196608
    s_lshl_b32 s97, s97, 7
    buffer_load_dwordx4 v10, s[36:39], s97 offen offset:0 lds
    buffer_load_dwordx4 v11, s[36:39], s97 offen offset:1024 lds
    buffer_load_dwordx4 v12, s[36:39], s97 offen offset:2048 lds
    buffer_load_dwordx4 v13, s[36:39], s97 offen offset:3072 lds
    s_add_u32 m0, s100, 32768
    s_cmp_eq_u32 s53, 1
    s_cselect_b32 s58, s97, s98
    s_mov_b64 exec, 0xff
    buffer_load_dwordx4 v18, s[44:47], s58 offen lds
    s_not_b64 exec, exec
    buffer_load_dwordx4 v14, s[40:43], s58 offen lds
    s_mov_b64 exec, -1
    buffer_load_dwordx4 v15, s[40:43], s58 offen offset:1024 lds
    s_add_u32 m0, s57, 32768
    s_nop 0
    buffer_load_dwordx4 v16, s[32:35], s98 offen lds
    buffer_load_dwordx4 v17, s[32:35], s98 offen offset:1024 lds
    s_lshl_b32 s59, s49, 2
    s_add_u32 s59, s59, s54
    s_lshl_b32 s59, s59, 16
    s_lshl_b32 s60, s51, 12
    s_add_u32 s59, s59, s60
    s_mov_b32 s96, s59
    s_cmp_eq_u32 s53, 1
    s_cselect_b32 s60, 0, 2097152
    s_add_u32 s60, s59, s60
    buffer_load_dwordx4 v[252:255], v2, s[28:31], s60 offen offset:0
    buffer_load_dwordx4 v[252:255], v2, s[28:31], s60 offen offset:1024
    buffer_load_dwordx4 v[252:255], v2, s[28:31], s60 offen offset:2048
    buffer_load_dwordx4 v[252:255], v2, s[28:31], s60 offen offset:3072
    s_waitcnt vmcnt(22)
    s_barrier
    s_add_u32 m0, s99, 65536
    s_add_u32 s97, s49, 6
    s_and_b32 s97, s97, 7
    s_mul_i32 s98, s97, 196608
    s_lshl_b32 s97, s97, 7
    buffer_load_dwordx4 v10, s[36:39], s97 offen offset:0 lds
    buffer_load_dwordx4 v11, s[36:39], s97 offen offset:1024 lds
    buffer_load_dwordx4 v12, s[36:39], s97 offen offset:2048 lds
    buffer_load_dwordx4 v13, s[36:39], s97 offen offset:3072 lds
    s_add_u32 m0, s100, 65536
    s_cmp_eq_u32 s53, 1
    s_cselect_b32 s58, s97, s98
    s_mov_b64 exec, 0xff
    buffer_load_dwordx4 v18, s[44:47], s58 offen lds
    s_not_b64 exec, exec
    buffer_load_dwordx4 v14, s[40:43], s58 offen lds
    s_mov_b64 exec, -1
    buffer_load_dwordx4 v15, s[40:43], s58 offen offset:1024 lds
    s_add_u32 m0, s57, 65536
    s_nop 0
    buffer_load_dwordx4 v16, s[32:35], s98 offen lds
    buffer_load_dwordx4 v17, s[32:35], s98 offen offset:1024 lds
    s_cmp_eq_u32 s53, 1
    s_cselect_b32 s60, 0, 4194304
    s_add_u32 s60, s96, s60
    buffer_load_dwordx4 v[252:255], v2, s[28:31], s60 offen offset:0
    buffer_load_dwordx4 v[252:255], v2, s[28:31], s60 offen offset:1024
    buffer_load_dwordx4 v[252:255], v2, s[28:31], s60 offen offset:2048
    buffer_load_dwordx4 v[252:255], v2, s[28:31], s60 offen offset:3072
    s_waitcnt vmcnt(26)
    s_barrier
    s_add_u32 m0, s99, 98304
    s_add_u32 s97, s49, 7
    s_and_b32 s97, s97, 7
    s_mul_i32 s98, s97, 196608
    s_lshl_b32 s97, s97, 7
    buffer_load_dwordx4 v10, s[36:39], s97 offen offset:0 lds
    buffer_load_dwordx4 v11, s[36:39], s97 offen offset:1024 lds
    buffer_load_dwordx4 v12, s[36:39], s97 offen offset:2048 lds
    buffer_load_dwordx4 v13, s[36:39], s97 offen offset:3072 lds
    s_add_u32 m0, s100, 98304
    s_cmp_eq_u32 s53, 1
    s_cselect_b32 s58, s97, s98
    s_mov_b64 exec, 0xff
    buffer_load_dwordx4 v18, s[44:47], s58 offen lds
    s_not_b64 exec, exec
    buffer_load_dwordx4 v14, s[40:43], s58 offen lds
    s_mov_b64 exec, -1
    buffer_load_dwordx4 v15, s[40:43], s58 offen offset:1024 lds
    s_add_u32 m0, s57, 98304
    s_nop 0
    buffer_load_dwordx4 v16, s[32:35], s98 offen lds
    buffer_load_dwordx4 v17, s[32:35], s98 offen offset:1024 lds
    s_waitcnt vmcnt(26)
    s_barrier
    s_mov_b32 s40, s8
    s_mov_b32 s41, s9
    s_mov_b32 s42, 0x80000
    s_mov_b32 s43, 0x20000
    s_lshl_b32 s59, s50, 14
    s_add_u32 s59, s59, s99
    buffer_load_dwordx4 v[252:255], v2, s[40:43], s59 offen offset:0
    buffer_load_dwordx4 v[252:255], v2, s[40:43], s59 offen offset:1024
    buffer_load_dwordx4 v[252:255], v2, s[40:43], s59 offen offset:2048
    buffer_load_dwordx4 v[252:255], v2, s[40:43], s59 offen offset:3072
    s_bitcmp1_b32 s54, 0
    s_cselect_b32 s44, s14, s12
    s_cselect_b32 s45, s15, s13
    s_mov_b32 s46, 0x800000
    s_mov_b32 s47, 0x20000
    v_lshlrev_b32 v6, 17, v1
    s_lshl_b32 s59, s55, 12
    buffer_load_dword v252, v6, s[44:47], s59 offen
    s_waitcnt vmcnt(18)
    s_barrier
    s_lshl_b32 s63, s48, 10
    s_add_u32 s63, s63, 106496
    v_add_u32 v234, s63, v2
    s_sub_u32 s16, 8, s48
    s_cmp_ge_u32 s56, 1
    s_cselect_b32 s16, 0, s16
    s_lshl_b32 s62, s48, 11
    s_add_u32 s62, s62, 131072
    v_add_u32 v220, s62, v2
    s_lshl_b32 s62, s48, 10
    s_add_u32 s62, s62, 131072
    v_add_u32 v223, s62, v2
    v_and_b32 v224, 15, v1
    v_lshlrev_b32 v224, 4, v224
    v_lshl_add_u32 v224, v5, 8, v224
    v_add_u32 v224, s62, v224
    v_add_u32 v224, 16384, v224
    v_mov_b32 v231, 86016
    v_cmp_gt_u32 vcc, 16, v4
    s_nop 1
    v_cndmask_b32 v224, v231, v224, vcc
    v_mul_u32_u24 v246, 272, v4
    v_lshl_add_u32 v246, v5, 7, v246
    s_lshl_b32 s62, s48, 4
    s_add_u32 s62, s62, 98304
    v_add_u32 v246, s62, v246
    v_lshrrev_b32 v247, 4, v1
    v_mul_u32_u24 v247, 272, v247
    v_and_b32 v231, 15, v1
    v_lshl_add_u32 v247, v231, 4, v247
    s_mul_i32 s62, s48, 1088
    s_add_u32 s62, s62, 98304
    v_add_u32 v247, s62, v247
    v_lshrrev_b32 v248, 4, v1
    v_lshlrev_b32 v248, 16, v248
    v_bfe_u32 v231, v1, 3, 1
    v_lshl_add_u32 v248, v231, 9, v248
    v_and_b32 v231, 7, v1
    v_lshl_add_u32 v248, v231, 4, v248
    s_lshl_b32 s17, s55, 11
    s_lshr_b32 s62, s56, 2
    s_lshl_b32 s62, s62, 10
    s_add_u32 s17, s17, s62
    s_and_b32 s62, s56, 3
    s_lshl_b32 s62, s62, 7
    s_add_u32 s17, s17, s62
    s_lshl_b32 s62, s48, 18
    s_add_u32 s17, s17, s62
    s_add_u32 s17, s17, 10485760
    v_mov_b32 v226, 0x3f803f80
    v_mov_b32 v227, 0x3f803f80
    v_mov_b32 v228, 0x3f803f80
    v_mov_b32 v229, 0x3f803f80
    v_min_u32 v225, 17, v1
    v_lshlrev_b32 v225, 9, v225
    v_add_u32 v225, 86016, v225
    s_lshl_b32 s62, s56, 1
    s_sub_i32 s62, s62, 2
    v_add_u32 v230, s62, v1
    v_max_i32 v230, 0, v230
    v_and_b32 v231, 15, v1
    v_add_u32 v231, 128, v231
    v_cmp_gt_u32 vcc, 4, v1
    s_nop 1
    v_cndmask_b32 v230, v231, v230, vcc
    s_lshl_b32 s62, s49, 4
    v_add_u32 v230, s62, v230
    v_lshlrev_b32 v230, 7, v230
    s_lshl_b32 s62, s56, 1
    s_sub_u32 s63, 14, s62
    s_cmp_ge_u32 s56, 4
    s_cselect_b32 s7, s63, s62
    v_lshrrev_b32 v221, 4, v1
    v_min_u32 v221, 2, v221
    v_add_u32 v221, s7, v221
    v_and_b32 v221, 7, v221
    v_and_b32 v231, 15, v1
    v_lshl_add_u32 v221, v221, 4, v231
    v_add_u32 v221, 256, v221
    v_lshlrev_b32 v221, 7, v221
    s_mov_b32 s19, 13631488
    s_waitcnt vmcnt(5)
    s_barrier
    v_bfe_u32 v6, v1, 2, 3
    v_and_b32 v7, 3, v1
    v_lshlrev_b32 v7, 4, v7
    v_lshl_add_u32 v7, v5, 6, v7
    v_lshl_add_u32 v10, v6, 10, v7
    v_add_u32 v11, 7168, v10
    v_add_u32 v12, 14336, v10
    v_add_u32 v13, 21504, v10
    s_lshl_b32 s59, s54, 17
    s_lshl_b32 s60, s56, 7
    s_add_u32 s59, s59, s60
    s_lshl_b32 s60, s54, 14
    s_mov_b32 s58, s59
    s_mov_b32 s57, s60
    s_add_u32 m0, s57, 0
    s_nop 0
    buffer_load_dwordx4 v10, s[40:43], s58 offen offset:0 lds
    buffer_load_dwordx4 v11, s[40:43], s58 offen offset:1024 lds
    buffer_load_dwordx4 v12, s[40:43], s58 offen offset:2048 lds
    buffer_load_dwordx4 v13, s[40:43], s58 offen offset:3072 lds
    s_add_u32 m0, s57, 4096
    s_add_u32 s58, s58, 32768
    buffer_load_dwordx4 v10, s[40:43], s58 offen offset:0 lds
    buffer_load_dwordx4 v11, s[40:43], s58 offen offset:1024 lds
    buffer_load_dwordx4 v12, s[40:43], s58 offen offset:2048 lds
    buffer_load_dwordx4 v13, s[40:43], s58 offen offset:3072 lds
    s_add_u32 m0, s57, 8192
    s_add_u32 s58, s58, 32768
    buffer_load_dwordx4 v10, s[40:43], s58 offen offset:0 lds
    buffer_load_dwordx4 v11, s[40:43], s58 offen offset:1024 lds
    buffer_load_dwordx4 v12, s[40:43], s58 offen offset:2048 lds
    buffer_load_dwordx4 v13, s[40:43], s58 offen offset:3072 lds
    s_add_u32 m0, s57, 12288
    s_add_u32 s58, s58, 32768
    buffer_load_dwordx4 v10, s[40:43], s58 offen offset:0 lds
    buffer_load_dwordx4 v11, s[40:43], s58 offen offset:1024 lds
    buffer_load_dwordx4 v12, s[40:43], s58 offen offset:2048 lds
    buffer_load_dwordx4 v13, s[40:43], s58 offen offset:3072 lds
    s_cmp_eq_u32 s53, 1
    s_cbranch_scc1 L_ustore
    s_branch L_p1done
L_compute:
    s_and_b32 s56, s50, 7
    s_lshr_b32 s59, s50, 3
    s_lshl_b32 s55, s49, 2
    s_add_u32 s55, s55, s59
    v_and_b32 v4, 31, v1
    v_lshrrev_b32 v5, 5, v1
    s_getreg_b32 s101, hwreg(HW_REG_XCC_ID, 0, 4)
    s_lshr_b32 s57, s54, 1
    s_and_b32 s58, s54, 1
    v_bfe_u32 v6, v1, 1, 3
    v_xor_b32 v6, v6, v5
    v_lshlrev_b32 v7, 7, v4
    v_xor_b32 v8, 0, v6
    v_lshl_add_u32 v20, v8, 4, v7
    v_xor_b32 v8, 2, v6
    v_lshl_add_u32 v21, v8, 4, v7
    v_xor_b32 v8, 4, v6
    v_lshl_add_u32 v22, v8, 4, v7
    v_xor_b32 v8, 6, v6
    v_lshl_add_u32 v23, v8, 4, v7
    v_bfe_u32 v8, v1, 2, 2
    v_lshlrev_b32 v8, 6, v8
    v_lshl_add_u32 v8, v5, 10, v8
    v_bfe_u32 v9, v1, 4, 1
    v_lshl_add_u32 v8, v9, 5, v8
    v_and_b32 v9, 3, v1
    v_lshl_add_u32 v18, v9, 3, v8
    v_mov_b32 v60, 0
    v_lshlrev_b32 v61, 2, v4
    s_add_u32 s101, s101, 1
    s_lshl_b32 s99, s49, 7
    s_add_u32 s99, s99, 13683712
    v_bfe_u32 v62, v1, 3, 2
    v_lshl_add_u32 v62, v5, 6, v62
    v_mul_u32_u24 v62, 3072, v62
    v_and_b32 v63, 7, v1
    v_lshl_add_u32 v62, v63, 4, v62
    s_lshl_b32 s60, s54, 7
    s_lshl_b32 s61, s51, 2
    s_add_u32 s60, s60, s61
    s_mul_i32 s60, s60, 3072
    s_lshl_b32 s61, s49, 7
    s_add_u32 s96, s60, s61
    s_waitcnt lgkmcnt(0)
    s_mov_b32 s28, s26
    s_mov_b32 s29, s27
    s_mov_b32 s30, 0xd10000
    s_mov_b32 s31, 0x20000
    s_mov_b32 s32, s24
    s_mov_b32 s33, s25
    s_mov_b32 s34, 0x100
    s_mov_b32 s35, 0x20000
    s_mov_b32 s40, s6
    s_mov_b32 s41, s7
    s_mov_b32 s42, 0x180000
    s_mov_b32 s43, 0x20000
    s_lshl_b32 s59, s48, 8
    s_or_b32 s59, s59, s2
    s_cmp_ge_u32 s59, 16
    s_cbranch_scc1 L_nozero
    v_lshlrev_b32 v52, 7, v1
    s_mul_i32 s59, s2, 3328
    s_add_u32 s59, s59, 13631488
    s_mov_b64 exec, 0x3ffffff
    buffer_store_dword v60, v52, s[28:31], s59 offen sc0 sc1
    s_mov_b64 exec, -1
    buffer_store_dword v60, v61, s[28:31], s99 offen sc0 sc1
    s_waitcnt vmcnt(0)
    s_mov_b64 exec, 1
    v_mov_b32 v52, 1
    buffer_atomic_add v52, v60, s[32:35], 0 offen sc1
    s_mov_b64 exec, -1
L_nozero:
    s_cmp_eq_u32 s53, 1
    s_cbranch_scc1 L_cz
    buffer_load_dwordx4 v[252:255], v62, s[40:43], s96 offen offset:1024
    buffer_load_dwordx4 v[252:255], v62, s[40:43], s96 offen offset:2048
    s_lshl_b32 s59, s57, 13
    v_add_u32 v10, s59, v20
    v_add_u32 v14, 65536, v10
    v_add_u32 v11, s59, v21
    v_add_u32 v15, 65536, v11
    v_add_u32 v12, s59, v22
    v_add_u32 v16, 65536, v12
    v_add_u32 v13, s59, v23
    v_add_u32 v17, 65536, v13
    s_lshl_b32 s59, s58, 9
    v_add_u32 v18, s59, v18
    v_add_u32 v19, 65536, v18
    s_lshl_b32 s59, s49, 2
    s_lshl_b32 s60, s58, 1
    s_add_u32 s59, s59, s60
    s_lshl_b32 s59, s59, 6
    s_lshl_b32 s60, s51, 2
    s_add_u32 s59, s59, s60
    s_lshl_b32 s60, s57, 1
    s_add_u32 s59, s59, s60
    s_lshl_b32 s59, s59, 10
    s_add_u32 s97, s59, 2097152
    s_add_u32 s98, s59, 4194304
    v_bfe_u32 v7, v1, 4, 1
    v_lshlrev_b32 v7, 16, v7
    v_lshl_add_u32 v7, v5, 8, v7
    v_and_b32 v8, 15, v1
    v_lshl_add_u32 v7, v8, 4, v7
    v_add_u32 v6, 65536, v2
    v_lshlrev_b32 v231, 2, v5
    v_sub_u32 v231, v4, v231
    v_cmp_le_i32 s[64:65], 0, v231
    v_cmp_le_i32 s[66:67], 1, v231
    v_cmp_le_i32 s[68:69], 2, v231
    v_cmp_le_i32 s[70:71], 3, v231
    v_cmp_le_i32 s[72:73], 8, v231
    v_cmp_le_i32 s[74:75], 9, v231
    v_cmp_le_i32 s[76:77], 10, v231
    v_cmp_le_i32 s[78:79], 11, v231
    v_cmp_le_i32 s[80:81], 16, v231
    v_cmp_le_i32 s[82:83], 17, v231
    v_cmp_le_i32 s[84:85], 18, v231
    v_cmp_le_i32 s[86:87], 19, v231
    v_cmp_le_i32 s[88:89], 24, v231
    v_cmp_le_i32 s[90:91], 25, v231
    v_cmp_le_i32 s[92:93], 26, v231
    v_cmp_le_i32 s[94:95], 27, v231
    v_mov_b32 v231, 0xffff
    v_mov_b32 v232, 0xffff0000
    v_cndmask_b32 v236, 0, v231, s[64:65]
    v_cndmask_b32 v52, 0, v232, s[66:67]
    v_cndmask_b32 v237, 0, v231, s[68:69]
    v_cndmask_b32 v53, 0, v232, s[70:71]
    v_cndmask_b32 v238, 0, v231, s[72:73]
    v_cndmask_b32 v54, 0, v232, s[74:75]
    v_cndmask_b32 v239, 0, v231, s[76:77]
    v_cndmask_b32 v55, 0, v232, s[78:79]
    v_cndmask_b32 v240, 0, v231, s[80:81]
    v_cndmask_b32 v56, 0, v232, s[82:83]
    v_cndmask_b32 v241, 0, v231, s[84:85]
    v_cndmask_b32 v57, 0, v232, s[86:87]
    v_cndmask_b32 v242, 0, v231, s[88:89]
    v_cndmask_b32 v58, 0, v232, s[90:91]
    v_cndmask_b32 v243, 0, v231, s[92:93]
    v_cndmask_b32 v59, 0, v232, s[94:95]
    v_or_b32 v236, v236, v52
    v_or_b32 v237, v237, v53
    v_or_b32 v238, v238, v54
    v_or_b32 v239, v239, v55
    v_or_b32 v240, v240, v56
    v_or_b32 v241, v241, v57
    v_or_b32 v242, v242, v58
    v_or_b32 v243, v243, v59
    v_mov_b32 v204, 0xf149f2ca
    v_mov_b32 v205, 0xf149f2ca
    v_mov_b32 v206, 0xf149f2ca
    v_mov_b32 v207, 0xf149f2ca
    v_mov_b32 v208, 0xf149f2ca
    v_mov_b32 v209, 0xf149f2ca
    v_mov_b32 v210, 0xf149f2ca
    v_mov_b32 v211, 0xf149f2ca
    v_mov_b32 v212, 0xf149f2ca
    v_mov_b32 v213, 0xf149f2ca
    v_mov_b32 v214, 0xf149f2ca
    v_mov_b32 v215, 0xf149f2ca
    v_mov_b32 v216, 0xf149f2ca
    v_mov_b32 v217, 0xf149f2ca
    v_mov_b32 v218, 0xf149f2ca
    v_mov_b32 v219, 0xf149f2ca
    s_lshl_b32 s62, s56, 3
    s_add_u32 s62, s62, s48
    s_add_u32 s4, s62, s48
    s_sub_i32 s4, s4, 8
    s_max_i32 s4, s4, 0
    s_lshl_b32 s63, s55, 6
    s_add_u32 s4, s4, s63
    s_lshl_b32 s4, s4, 10
    s_add_u32 s4, s4, 2097152
    s_add_u32 s5, s4, 2097152
    s_lshl_b32 s6, s55, 16
    s_lshl_b32 s63, s48, 13
    s_add_u32 s6, s6, s63
    s_lshl_b32 s63, s56, 6
    s_add_u32 s6, s6, s63
    v_lshrrev_b32 v222, 2, v1
    v_lshlrev_b32 v222, 9, v222
    v_and_b32 v231, 3, v1
    v_lshl_add_u32 v222, v231, 4, v222
    v_lshlrev_b32 v233, 11, v231
    v_bfe_u32 v231, v1, 2, 1
    v_lshl_add_u32 v233, v231, 9, v233
    v_lshrrev_b32 v231, 3, v1
    v_lshl_add_u32 v233, v231, 4, v233
    s_lshr_b32 s63, s48, 2
    s_lshl_b32 s63, s63, 10
    s_lshl_b32 s62, s54, 7
    s_add_u32 s63, s63, s62
    s_add_u32 s63, s63, 106496
    v_add_u32 v233, s63, v233
    s_lshl_b32 s63, s48, 10
    s_add_u32 s63, s63, 106496
    v_add_u32 v234, s63, v2
    s_sub_u32 s16, 8, s48
    s_cmp_ge_u32 s56, 1
    s_cselect_b32 s16, 0, s16
    s_lshl_b32 s62, s48, 11
    s_add_u32 s62, s62, 131072
    v_add_u32 v220, s62, v2
    s_lshl_b32 s62, s48, 10
    s_add_u32 s62, s62, 131072
    v_add_u32 v223, s62, v2
    v_and_b32 v224, 15, v1
    v_lshlrev_b32 v224, 4, v224
    v_lshl_add_u32 v224, v5, 8, v224
    v_add_u32 v224, s62, v224
    v_add_u32 v224, 16384, v224
    v_mov_b32 v231, 86016
    v_cmp_gt_u32 vcc, 16, v4
    s_nop 1
    v_cndmask_b32 v224, v231, v224, vcc
    v_mul_u32_u24 v246, 272, v4
    v_lshl_add_u32 v246, v5, 7, v246
    s_lshl_b32 s62, s48, 4
    s_add_u32 s62, s62, 98304
    v_add_u32 v246, s62, v246
    v_lshrrev_b32 v247, 4, v1
    v_mul_u32_u24 v247, 272, v247
    v_and_b32 v231, 15, v1
    v_lshl_add_u32 v247, v231, 4, v247
    s_mul_i32 s62, s48, 1088
    s_add_u32 s62, s62, 98304
    v_add_u32 v247, s62, v247
    v_lshrrev_b32 v248, 4, v1
    v_lshlrev_b32 v248, 16, v248
    v_bfe_u32 v231, v1, 3, 1
    v_lshl_add_u32 v248, v231, 9, v248
    v_and_b32 v231, 7, v1
    v_lshl_add_u32 v248, v231, 4, v248
    s_lshl_b32 s17, s55, 11
    s_lshr_b32 s62, s56, 2
    s_lshl_b32 s62, s62, 10
    s_add_u32 s17, s17, s62
    s_and_b32 s62, s56, 3
    s_lshl_b32 s62, s62, 7
    s_add_u32 s17, s17, s62
    s_lshl_b32 s62, s48, 18
    s_add_u32 s17, s17, s62
    s_add_u32 s17, s17, 10485760
    v_mov_b32 v226, 0x3f803f80
    v_mov_b32 v227, 0x3f803f80
    v_mov_b32 v228, 0x3f803f80
    v_mov_b32 v229, 0x3f803f80
    v_min_u32 v225, 17, v1
    v_lshlrev_b32 v225, 9, v225
    v_add_u32 v225, 86016, v225
    s_lshl_b32 s62, s56, 1
    s_sub_i32 s62, s62, 2
    v_add_u32 v230, s62, v1
    v_max_i32 v230, 0, v230
    v_and_b32 v231, 15, v1
    v_add_u32 v231, 128, v231
    v_cmp_gt_u32 vcc, 4, v1
    s_nop 1
    v_cndmask_b32 v230, v231, v230, vcc
    s_lshl_b32 s62, s49, 4
    v_add_u32 v230, s62, v230
    v_lshlrev_b32 v230, 7, v230
    s_lshl_b32 s62, s56, 1
    s_sub_u32 s63, 14, s62
    s_cmp_ge_u32 s56, 4
    s_cselect_b32 s7, s63, s62
    v_lshrrev_b32 v221, 4, v1
    v_min_u32 v221, 2, v221
    v_add_u32 v221, s7, v221
    v_and_b32 v221, 7, v221
    v_and_b32 v231, 15, v1
    v_lshl_add_u32 v221, v221, 4, v231
    v_add_u32 v221, 256, v221
    v_lshlrev_b32 v221, 7, v221
    s_mov_b32 s19, 13631488
    s_barrier
    ds_read_b128 v[160:163], v10 offset:0
    ds_read_b64_tr_b16 v[168:169], v18 offset:16384
    ds_read_b64_tr_b16 v[170:171], v18 offset:16640
    ds_read_b128 v[164:167], v10 offset:4096
    ds_read_b64_tr_b16 v[172:173], v18 offset:24576
    ds_read_b64_tr_b16 v[174:175], v18 offset:24832
    s_waitcnt lgkmcnt(3)
    v_mfma_f32_32x32x16_bf16 v[64:79], v[168:171], v[160:163], 0
    ds_read_b128 v[176:179], v11 offset:0
    ds_read_b64_tr_b16 v[184:185], v18 offset:18432
    s_waitcnt lgkmcnt(4)
    v_mfma_f32_32x32x16_bf16 v[80:95], v[168:171], v[164:167], 0
    ds_read_b64_tr_b16 v[186:187], v18 offset:18688
    ds_read_b128 v[180:183], v11 offset:4096
    s_waitcnt lgkmcnt(4)
    v_mfma_f32_32x32x16_bf16 v[96:111], v[160:163], v[172:175], 0
    ds_read_b64_tr_b16 v[188:189], v18 offset:26624
    ds_read_b64_tr_b16 v[190:191], v18 offset:26880
    v_mfma_f32_32x32x16_bf16 v[112:127], v[164:167], v[172:175], 0
    s_waitcnt lgkmcnt(3)
    v_mfma_f32_32x32x16_bf16 v[64:79], v[184:187], v[176:179], v[64:79]
    ds_read_b128 v[160:163], v12 offset:0
    ds_read_b64_tr_b16 v[168:169], v18 offset:20480
    s_waitcnt lgkmcnt(4)
    v_mfma_f32_32x32x16_bf16 v[80:95], v[184:187], v[180:183], v[80:95]
    ds_read_b64_tr_b16 v[170:171], v18 offset:20736
    ds_read_b128 v[164:167], v12 offset:4096
    s_waitcnt lgkmcnt(4)
    v_mfma_f32_32x32x16_bf16 v[96:111], v[176:179], v[188:191], v[96:111]
    ds_read_b64_tr_b16 v[172:173], v18 offset:28672
    ds_read_b64_tr_b16 v[174:175], v18 offset:28928
    v_mfma_f32_32x32x16_bf16 v[112:127], v[180:183], v[188:191], v[112:127]
    s_cmp_lg_u32 s48, 1
    s_cbranch_scc1 L_m1_nodz
    buffer_load_dword v62, v60, s[32:35], 0 offen sc0 sc1
L_m1_nodz:
    s_waitcnt lgkmcnt(3)
    v_mfma_f32_32x32x16_bf16 v[64:79], v[168:171], v[160:163], v[64:79]
    ds_read_b128 v[176:179], v13 offset:0
    ds_read_b64_tr_b16 v[184:185], v18 offset:22528
    s_waitcnt lgkmcnt(4)
    v_mfma_f32_32x32x16_bf16 v[80:95], v[168:171], v[164:167], v[80:95]
    ds_read_b64_tr_b16 v[186:187], v18 offset:22784
    ds_read_b128 v[180:183], v13 offset:4096
    s_waitcnt lgkmcnt(4)
    v_mfma_f32_32x32x16_bf16 v[96:111], v[160:163], v[172:175], v[96:111]
    ds_read_b64_tr_b16 v[188:189], v18 offset:30720
    ds_read_b64_tr_b16 v[190:191], v18 offset:30976
    v_mfma_f32_32x32x16_bf16 v[112:127], v[164:167], v[172:175], v[112:127]
    s_waitcnt lgkmcnt(3)
    v_mfma_f32_32x32x16_bf16 v[64:79], v[184:187], v[176:179], v[64:79]
    s_waitcnt lgkmcnt(0)
    s_barrier
    ds_read_b128 v[160:163], v10 offset:32768
    ds_read_b64_tr_b16 v[168:169], v18 offset:49152
    v_mfma_f32_32x32x16_bf16 v[80:95], v[184:187], v[180:183], v[80:95]
    ds_read_b64_tr_b16 v[170:171], v18 offset:49408
    ds_read_b128 v[164:167], v10 offset:36864
    v_mfma_f32_32x32x16_bf16 v[96:111], v[176:179], v[188:191], v[96:111]
    ds_read_b64_tr_b16 v[172:173], v18 offset:57344
    ds_read_b64_tr_b16 v[174:175], v18 offset:57600
    v_mfma_f32_32x32x16_bf16 v[112:127], v[180:183], v[188:191], v[112:127]
    s_waitcnt lgkmcnt(3)
    v_mfma_f32_32x32x16_bf16 v[64:79], v[168:171], v[160:163], v[64:79]
    ds_read_b128 v[176:179], v11 offset:32768
    ds_read_b64_tr_b16 v[184:185], v18 offset:51200
    s_waitcnt lgkmcnt(4)
    v_mfma_f32_32x32x16_bf16 v[80:95], v[168:171], v[164:167], v[80:95]
    ds_read_b64_tr_b16 v[186:187], v18 offset:51456
    ds_read_b128 v[180:183], v11 offset:36864
    s_waitcnt lgkmcnt(4)
    v_mfma_f32_32x32x16_bf16 v[96:111], v[160:163], v[172:175], v[96:111]
    ds_read_b64_tr_b16 v[188:189], v18 offset:59392
    ds_read_b64_tr_b16 v[190:191], v18 offset:59648
    v_mfma_f32_32x32x16_bf16 v[112:127], v[164:167], v[172:175], v[112:127]
    s_waitcnt lgkmcnt(3)
    v_mfma_f32_32x32x16_bf16 v[64:79], v[184:187], v[176:179], v[64:79]
    ds_read_b128 v[160:163], v12 offset:32768
    ds_read_b64_tr_b16 v[168:169], v18 offset:53248
    s_waitcnt lgkmcnt(4)
    v_mfma_f32_32x32x16_bf16 v[80:95], v[184:187], v[180:183], v[80:95]
    ds_read_b64_tr_b16 v[170:171], v18 offset:53504
    ds_read_b128 v[164:167], v12 offset:36864
    s_waitcnt lgkmcnt(4)
    v_mfma_f32_32x32x16_bf16 v[96:111], v[176:179], v[188:191], v[96:111]
    ds_read_b64_tr_b16 v[172:173], v18 offset:61440
    ds_read_b64_tr_b16 v[174:175], v18 offset:61696
    v_mfma_f32_32x32x16_bf16 v[112:127], v[180:183], v[188:191], v[112:127]
    s_waitcnt lgkmcnt(3)
    v_mfma_f32_32x32x16_bf16 v[64:79], v[168:171], v[160:163], v[64:79]
    ds_read_b128 v[176:179], v13 offset:32768
    ds_read_b64_tr_b16 v[184:185], v18 offset:55296
    s_waitcnt lgkmcnt(4)
    v_mfma_f32_32x32x16_bf16 v[80:95], v[168:171], v[164:167], v[80:95]
    ds_read_b64_tr_b16 v[186:187], v18 offset:55552
    ds_read_b128 v[180:183], v13 offset:36864
    s_waitcnt lgkmcnt(4)
    v_mfma_f32_32x32x16_bf16 v[96:111], v[160:163], v[172:175], v[96:111]
    ds_read_b64_tr_b16 v[188:189], v18 offset:63488
    ds_read_b64_tr_b16 v[190:191], v18 offset:63744
    v_mfma_f32_32x32x16_bf16 v[112:127], v[164:167], v[172:175], v[112:127]
    s_waitcnt lgkmcnt(3)
    v_mfma_f32_32x32x16_bf16 v[64:79], v[184:187], v[176:179], v[64:79]
    s_waitcnt lgkmcnt(0)
    s_barrier
    ds_read_b128 v[160:163], v14 offset:0
    ds_read_b64_tr_b16 v[168:169], v19 offset:16384
    v_mfma_f32_32x32x16_bf16 v[80:95], v[184:187], v[180:183], v[80:95]
    ds_read_b64_tr_b16 v[170:171], v19 offset:16640
    ds_read_b128 v[164:167], v14 offset:4096
    v_mfma_f32_32x32x16_bf16 v[96:111], v[176:179], v[188:191], v[96:111]
    ds_read_b64_tr_b16 v[172:173], v19 offset:24576
    ds_read_b64_tr_b16 v[174:175], v19 offset:24832
    v_mfma_f32_32x32x16_bf16 v[112:127], v[180:183], v[188:191], v[112:127]
    s_waitcnt lgkmcnt(3)
    v_mfma_f32_32x32x16_bf16 v[64:79], v[168:171], v[160:163], v[64:79]
    ds_read_b128 v[176:179], v15 offset:0
    ds_read_b64_tr_b16 v[184:185], v19 offset:18432
    s_waitcnt lgkmcnt(4)
    v_mfma_f32_32x32x16_bf16 v[80:95], v[168:171], v[164:167], v[80:95]
    ds_read_b64_tr_b16 v[186:187], v19 offset:18688
    ds_read_b128 v[180:183], v15 offset:4096
    s_waitcnt lgkmcnt(4)
    v_mfma_f32_32x32x16_bf16 v[96:111], v[160:163], v[172:175], v[96:111]
    ds_read_b64_tr_b16 v[188:189], v19 offset:26624
    ds_read_b64_tr_b16 v[190:191], v19 offset:26880
    v_mfma_f32_32x32x16_bf16 v[112:127], v[164:167], v[172:175], v[112:127]
    s_waitcnt lgkmcnt(3)
    v_mfma_f32_32x32x16_bf16 v[64:79], v[184:187], v[176:179], v[64:79]
    ds_read_b128 v[160:163], v16 offset:0
    ds_read_b64_tr_b16 v[168:169], v19 offset:20480
    s_waitcnt lgkmcnt(4)
    v_mfma_f32_32x32x16_bf16 v[80:95], v[184:187], v[180:183], v[80:95]
    ds_read_b64_tr_b16 v[170:171], v19 offset:20736
    ds_read_b128 v[164:167], v16 offset:4096
    s_waitcnt lgkmcnt(4)
    v_mfma_f32_32x32x16_bf16 v[96:111], v[176:179], v[188:191], v[96:111]
    ds_read_b64_tr_b16 v[172:173], v19 offset:28672
    ds_read_b64_tr_b16 v[174:175], v19 offset:28928
    v_mfma_f32_32x32x16_bf16 v[112:127], v[180:183], v[188:191], v[112:127]
    s_cmp_lg_u32 s48, 1
    s_cbranch_scc1 L_m1_nopub
    s_waitcnt vmcnt(0)
    v_cmp_le_u32 vcc, 16, v62
    s_nop 1
    s_cmp_eq_u64 vcc, exec
    s_cbranch_scc0 L_m1z_slow
L_m1z_back:
    s_lshl_b32 s59, s50, 2
    v_mov_b32 v62, s59
    v_mov_b32 v63, s101
    s_mov_b64 exec, 1
    buffer_store_dword v63, v62, s[28:31], s99 offen sc0 sc1
    s_mov_b64 exec, -1
L_m1_nopub:
    s_waitcnt lgkmcnt(3)
    v_mfma_f32_32x32x16_bf16 v[64:79], v[168:171], v[160:163], v[64:79]
    ds_read_b128 v[176:179], v17 offset:0
    ds_read_b64_tr_b16 v[184:185], v19 offset:22528
    s_waitcnt lgkmcnt(4)
    v_mfma_f32_32x32x16_bf16 v[80:95], v[168:171], v[164:167], v[80:95]
    ds_read_b64_tr_b16 v[186:187], v19 offset:22784
    ds_read_b128 v[180:183], v17 offset:4096
    s_waitcnt lgkmcnt(4)
    v_mfma_f32_32x32x16_bf16 v[96:111], v[160:163], v[172:175], v[96:111]
    ds_read_b64_tr_b16 v[188:189], v19 offset:30720
    ds_read_b64_tr_b16 v[190:191], v19 offset:30976
    v_mfma_f32_32x32x16_bf16 v[112:127], v[164:167], v[172:175], v[112:127]
    s_waitcnt lgkmcnt(3)
    v_mfma_f32_32x32x16_bf16 v[64:79], v[184:187], v[176:179], v[64:79]
    s_waitcnt lgkmcnt(0)
    s_barrier
    ds_read_b128 v[160:163], v14 offset:32768
    ds_read_b64_tr_b16 v[168:169], v19 offset:49152
    v_mfma_f32_32x32x16_bf16 v[80:95], v[184:187], v[180:183], v[80:95]
    ds_read_b64_tr_b16 v[170:171], v19 offset:49408
    ds_read_b128 v[164:167], v14 offset:36864
    v_mfma_f32_32x32x16_bf16 v[96:111], v[176:179], v[188:191], v[96:111]
    ds_read_b64_tr_b16 v[172:173], v19 offset:57344
    ds_read_b64_tr_b16 v[174:175], v19 offset:57600
    v_mfma_f32_32x32x16_bf16 v[112:127], v[180:183], v[188:191], v[112:127]
    s_waitcnt lgkmcnt(3)
    v_mfma_f32_32x32x16_bf16 v[64:79], v[168:171], v[160:163], v[64:79]
    ds_read_b128 v[176:179], v15 offset:32768
    ds_read_b64_tr_b16 v[184:185], v19 offset:51200
    s_waitcnt lgkmcnt(4)
    v_mfma_f32_32x32x16_bf16 v[80:95], v[168:171], v[164:167], v[80:95]
    ds_read_b64_tr_b16 v[186:187], v19 offset:51456
    ds_read_b128 v[180:183], v15 offset:36864
    s_waitcnt lgkmcnt(4)
    v_mfma_f32_32x32x16_bf16 v[96:111], v[160:163], v[172:175], v[96:111]
    ds_read_b64_tr_b16 v[188:189], v19 offset:59392
    ds_read_b64_tr_b16 v[190:191], v19 offset:59648
    v_mfma_f32_32x32x16_bf16 v[112:127], v[164:167], v[172:175], v[112:127]
    s_waitcnt lgkmcnt(3)
    v_mfma_f32_32x32x16_bf16 v[64:79], v[184:187], v[176:179], v[64:79]
    ds_read_b128 v[160:163], v16 offset:32768
    ds_read_b64_tr_b16 v[168:169], v19 offset:53248
    s_waitcnt lgkmcnt(4)
    v_mfma_f32_32x32x16_bf16 v[80:95], v[184:187], v[180:183], v[80:95]
    ds_read_b64_tr_b16 v[170:171], v19 offset:53504
    ds_read_b128 v[164:167], v16 offset:36864
    s_waitcnt lgkmcnt(4)
    v_mfma_f32_32x32x16_bf16 v[96:111], v[176:179], v[188:191], v[96:111]
    ds_read_b64_tr_b16 v[172:173], v19 offset:61440
    ds_read_b64_tr_b16 v[174:175], v19 offset:61696
    v_mfma_f32_32x32x16_bf16 v[112:127], v[180:183], v[188:191], v[112:127]
    s_waitcnt lgkmcnt(3)
    v_mfma_f32_32x32x16_bf16 v[64:79], v[168:171], v[160:163], v[64:79]
    ds_read_b128 v[176:179], v17 offset:32768
    ds_read_b64_tr_b16 v[184:185], v19 offset:55296
    s_waitcnt lgkmcnt(4)
    v_mfma_f32_32x32x16_bf16 v[80:95], v[168:171], v[164:167], v[80:95]
    ds_read_b64_tr_b16 v[186:187], v19 offset:55552
    ds_read_b128 v[180:183], v17 offset:36864
    s_waitcnt lgkmcnt(4)
    v_mfma_f32_32x32x16_bf16 v[96:111], v[160:163], v[172:175], v[96:111]
    ds_read_b64_tr_b16 v[188:189], v19 offset:63488
    ds_read_b64_tr_b16 v[190:191], v19 offset:63744
    v_mfma_f32_32x32x16_bf16 v[112:127], v[164:167], v[172:175], v[112:127]
    s_waitcnt lgkmcnt(3)
    v_mfma_f32_32x32x16_bf16 v[64:79], v[184:187], v[176:179], v[64:79]
    s_waitcnt lgkmcnt(0)
    s_barrier
    ds_read_b128 v[160:163], v10 offset:0
    ds_read_b64_tr_b16 v[168:169], v18 offset:16384
    v_mfma_f32_32x32x16_bf16 v[80:95], v[184:187], v[180:183], v[80:95]
    ds_read_b64_tr_b16 v[170:171], v18 offset:16640
    ds_read_b128 v[164:167], v10 offset:4096
    v_mfma_f32_32x32x16_bf16 v[96:111], v[176:179], v[188:191], v[96:111]
    ds_read_b64_tr_b16 v[172:173], v18 offset:24576
    ds_read_b64_tr_b16 v[174:175], v18 offset:24832
    v_mfma_f32_32x32x16_bf16 v[112:127], v[180:183], v[188:191], v[112:127]
    s_waitcnt lgkmcnt(3)
    v_mfma_f32_32x32x16_bf16 v[64:79], v[168:171], v[160:163], v[64:79]
    ds_read_b128 v[176:179], v11 offset:0
    ds_read_b64_tr_b16 v[184:185], v18 offset:18432
    s_waitcnt lgkmcnt(4)
    v_mfma_f32_32x32x16_bf16 v[80:95], v[168:171], v[164:167], v[80:95]
    ds_read_b64_tr_b16 v[186:187], v18 offset:18688
    ds_read_b128 v[180:183], v11 offset:4096
    s_waitcnt lgkmcnt(4)
    v_mfma_f32_32x32x16_bf16 v[96:111], v[160:163], v[172:175], v[96:111]
    ds_read_b64_tr_b16 v[188:189], v18 offset:26624
    ds_read_b64_tr_b16 v[190:191], v18 offset:26880
    v_mfma_f32_32x32x16_bf16 v[112:127], v[164:167], v[172:175], v[112:127]
    s_waitcnt lgkmcnt(3)
    v_mfma_f32_32x32x16_bf16 v[64:79], v[184:187], v[176:179], v[64:79]
    ds_read_b128 v[160:163], v12 offset:0
    ds_read_b64_tr_b16 v[168:169], v18 offset:20480
    s_waitcnt lgkmcnt(4)
    v_mfma_f32_32x32x16_bf16 v[80:95], v[184:187], v[180:183], v[80:95]
    ds_read_b64_tr_b16 v[170:171], v18 offset:20736
    ds_read_b128 v[164:167], v12 offset:4096
    s_waitcnt lgkmcnt(4)
    v_mfma_f32_32x32x16_bf16 v[96:111], v[176:179], v[188:191], v[96:111]
    ds_read_b64_tr_b16 v[172:173], v18 offset:28672
    ds_read_b64_tr_b16 v[174:175], v18 offset:28928
    v_mfma_f32_32x32x16_bf16 v[112:127], v[180:183], v[188:191], v[112:127]
    s_waitcnt lgkmcnt(3)
    v_mfma_f32_32x32x16_bf16 v[64:79], v[168:171], v[160:163], v[64:79]
    ds_read_b128 v[176:179], v13 offset:0
    ds_read_b64_tr_b16 v[184:185], v18 offset:22528
    s_waitcnt lgkmcnt(4)
    v_mfma_f32_32x32x16_bf16 v[80:95], v[168:171], v[164:167], v[80:95]
    ds_read_b64_tr_b16 v[186:187], v18 offset:22784
    ds_read_b128 v[180:183], v13 offset:4096
    s_waitcnt lgkmcnt(4)
    v_mfma_f32_32x32x16_bf16 v[96:111], v[160:163], v[172:175], v[96:111]
    ds_read_b64_tr_b16 v[188:189], v18 offset:30720
    ds_read_b64_tr_b16 v[190:191], v18 offset:30976
    v_mfma_f32_32x32x16_bf16 v[112:127], v[164:167], v[172:175], v[112:127]
    s_waitcnt lgkmcnt(3)
    v_mfma_f32_32x32x16_bf16 v[64:79], v[184:187], v[176:179], v[64:79]
    s_waitcnt lgkmcnt(0)
    s_barrier
    ds_read_b128 v[160:163], v10 offset:32768
    ds_read_b64_tr_b16 v[168:169], v18 offset:49152
    v_mfma_f32_32x32x16_bf16 v[80:95], v[184:187], v[180:183], v[80:95]
    ds_read_b64_tr_b16 v[170:171], v18 offset:49408
    ds_read_b128 v[164:167], v10 offset:36864
    v_mfma_f32_32x32x16_bf16 v[96:111], v[176:179], v[188:191], v[96:111]
    ds_read_b64_tr_b16 v[172:173], v18 offset:57344
    ds_read_b64_tr_b16 v[174:175], v18 offset:57600
    v_mfma_f32_32x32x16_bf16 v[112:127], v[180:183], v[188:191], v[112:127]
    buffer_load_dword v62, v61, s[28:31], s99 offen sc0 sc1
    s_waitcnt lgkmcnt(3)
    v_mfma_f32_32x32x16_bf16 v[64:79], v[168:171], v[160:163], v[64:79]
    ds_read_b128 v[176:179], v11 offset:32768
    ds_read_b64_tr_b16 v[184:185], v18 offset:51200
    s_waitcnt lgkmcnt(4)
    v_mfma_f32_32x32x16_bf16 v[80:95], v[168:171], v[164:167], v[80:95]
    ds_read_b64_tr_b16 v[186:187], v18 offset:51456
    ds_read_b128 v[180:183], v11 offset:36864
    s_waitcnt lgkmcnt(4)
    v_mfma_f32_32x32x16_bf16 v[96:111], v[160:163], v[172:175], v[96:111]
    ds_read_b64_tr_b16 v[188:189], v18 offset:59392
    ds_read_b64_tr_b16 v[190:191], v18 offset:59648
    v_mfma_f32_32x32x16_bf16 v[112:127], v[164:167], v[172:175], v[112:127]
    s_waitcnt lgkmcnt(3)
    v_mfma_f32_32x32x16_bf16 v[64:79], v[184:187], v[176:179], v[64:79]
    ds_read_b128 v[160:163], v12 offset:32768
    ds_read_b64_tr_b16 v[168:169], v18 offset:53248
    s_waitcnt lgkmcnt(4)
    v_mfma_f32_32x32x16_bf16 v[80:95], v[184:187], v[180:183], v[80:95]
    ds_read_b64_tr_b16 v[170:171], v18 offset:53504
    ds_read_b128 v[164:167], v12 offset:36864
    s_waitcnt lgkmcnt(4)
    v_mfma_f32_32x32x16_bf16 v[96:111], v[176:179], v[188:191], v[96:111]
    ds_read_b64_tr_b16 v[172:173], v18 offset:61440
    ds_read_b64_tr_b16 v[174:175], v18 offset:61696
    v_mfma_f32_32x32x16_bf16 v[112:127], v[180:183], v[188:191], v[112:127]
    s_waitcnt lgkmcnt(3)
    v_mfma_f32_32x32x16_bf16 v[64:79], v[168:171], v[160:163], v[64:79]
    ds_read_b128 v[176:179], v13 offset:32768
    ds_read_b64_tr_b16 v[184:185], v18 offset:55296
    s_waitcnt lgkmcnt(4)
    v_mfma_f32_32x32x16_bf16 v[80:95], v[168:171], v[164:167], v[80:95]
    ds_read_b64_tr_b16 v[186:187], v18 offset:55552
    ds_read_b128 v[180:183], v13 offset:36864
    s_waitcnt lgkmcnt(4)
    v_mfma_f32_32x32x16_bf16 v[96:111], v[160:163], v[172:175], v[96:111]
    ds_read_b64_tr_b16 v[188:189], v18 offset:63488
    ds_read_b64_tr_b16 v[190:191], v18 offset:63744
    v_mfma_f32_32x32x16_bf16 v[112:127], v[164:167], v[172:175], v[112:127]
    s_waitcnt lgkmcnt(3)
    v_mfma_f32_32x32x16_bf16 v[64:79], v[184:187], v[176:179], v[64:79]
    s_waitcnt lgkmcnt(0)
    s_barrier
    ds_read_b128 v[160:163], v14 offset:0
    ds_read_b64_tr_b16 v[168:169], v19 offset:16384
    v_mfma_f32_32x32x16_bf16 v[80:95], v[184:187], v[180:183], v[80:95]
    ds_read_b64_tr_b16 v[170:171], v19 offset:16640
    ds_read_b128 v[164:167], v14 offset:4096
    v_mfma_f32_32x32x16_bf16 v[96:111], v[176:179], v[188:191], v[96:111]
    ds_read_b64_tr_b16 v[172:173], v19 offset:24576
    ds_read_b64_tr_b16 v[174:175], v19 offset:24832
    v_mfma_f32_32x32x16_bf16 v[112:127], v[180:183], v[188:191], v[112:127]
    s_waitcnt lgkmcnt(3)
    v_mfma_f32_32x32x16_bf16 v[64:79], v[168:171], v[160:163], v[64:79]
    ds_read_b128 v[176:179], v15 offset:0
    ds_read_b64_tr_b16 v[184:185], v19 offset:18432
    s_waitcnt lgkmcnt(4)
    v_mfma_f32_32x32x16_bf16 v[80:95], v[168:171], v[164:167], v[80:95]
    ds_read_b64_tr_b16 v[186:187], v19 offset:18688
    ds_read_b128 v[180:183], v15 offset:4096
    s_waitcnt lgkmcnt(4)
    v_mfma_f32_32x32x16_bf16 v[96:111], v[160:163], v[172:175], v[96:111]
    ds_read_b64_tr_b16 v[188:189], v19 offset:26624
    ds_read_b64_tr_b16 v[190:191], v19 offset:26880
    v_mfma_f32_32x32x16_bf16 v[112:127], v[164:167], v[172:175], v[112:127]
    s_waitcnt lgkmcnt(3)
    v_mfma_f32_32x32x16_bf16 v[64:79], v[184:187], v[176:179], v[64:79]
    ds_read_b128 v[160:163], v16 offset:0
    ds_read_b64_tr_b16 v[168:169], v19 offset:20480
    s_waitcnt lgkmcnt(4)
    v_mfma_f32_32x32x16_bf16 v[80:95], v[184:187], v[180:183], v[80:95]
    ds_read_b64_tr_b16 v[170:171], v19 offset:20736
    ds_read_b128 v[164:167], v16 offset:4096
    s_waitcnt lgkmcnt(4)
    v_mfma_f32_32x32x16_bf16 v[96:111], v[176:179], v[188:191], v[96:111]
    ds_read_b64_tr_b16 v[172:173], v19 offset:28672
    ds_read_b64_tr_b16 v[174:175], v19 offset:28928
    v_mfma_f32_32x32x16_bf16 v[112:127], v[180:183], v[188:191], v[112:127]
    s_waitcnt lgkmcnt(3)
    v_mfma_f32_32x32x16_bf16 v[64:79], v[168:171], v[160:163], v[64:79]
    ds_read_b128 v[176:179], v17 offset:0
    ds_read_b64_tr_b16 v[184:185], v19 offset:22528
    s_waitcnt lgkmcnt(4)
    v_mfma_f32_32x32x16_bf16 v[80:95], v[168:171], v[164:167], v[80:95]
    ds_read_b64_tr_b16 v[186:187], v19 offset:22784
    ds_read_b128 v[180:183], v17 offset:4096
    s_waitcnt lgkmcnt(4)
    v_mfma_f32_32x32x16_bf16 v[96:111], v[160:163], v[172:175], v[96:111]
    ds_read_b64_tr_b16 v[188:189], v19 offset:30720
    ds_read_b64_tr_b16 v[190:191], v19 offset:30976
    v_mfma_f32_32x32x16_bf16 v[112:127], v[164:167], v[172:175], v[112:127]
    s_waitcnt lgkmcnt(3)
    v_mfma_f32_32x32x16_bf16 v[64:79], v[184:187], v[176:179], v[64:79]
    s_waitcnt lgkmcnt(0)
    s_barrier
    ds_read_b128 v[160:163], v14 offset:32768
    ds_read_b64_tr_b16 v[168:169], v19 offset:49152
    v_mfma_f32_32x32x16_bf16 v[80:95], v[184:187], v[180:183], v[80:95]
    ds_read_b64_tr_b16 v[170:171], v19 offset:49408
    ds_read_b128 v[164:167], v14 offset:36864
    v_mfma_f32_32x32x16_bf16 v[96:111], v[176:179], v[188:191], v[96:111]
    ds_read_b64_tr_b16 v[172:173], v19 offset:57344
    ds_read_b64_tr_b16 v[174:175], v19 offset:57600
    v_mfma_f32_32x32x16_bf16 v[112:127], v[180:183], v[188:191], v[112:127]
    s_waitcnt lgkmcnt(3)
    v_mfma_f32_32x32x16_bf16 v[64:79], v[168:171], v[160:163], v[64:79]
    ds_read_b128 v[176:179], v15 offset:32768
    ds_read_b64_tr_b16 v[184:185], v19 offset:51200
    s_waitcnt lgkmcnt(4)
    v_mfma_f32_32x32x16_bf16 v[80:95], v[168:171], v[164:167], v[80:95]
    ds_read_b64_tr_b16 v[186:187], v19 offset:51456
    ds_read_b128 v[180:183], v15 offset:36864
    s_waitcnt lgkmcnt(4)
    v_mfma_f32_32x32x16_bf16 v[96:111], v[160:163], v[172:175], v[96:111]
    ds_read_b64_tr_b16 v[188:189], v19 offset:59392
    ds_read_b64_tr_b16 v[190:191], v19 offset:59648
    v_mfma_f32_32x32x16_bf16 v[112:127], v[164:167], v[172:175], v[112:127]
    s_waitcnt lgkmcnt(3)
    v_mfma_f32_32x32x16_bf16 v[64:79], v[184:187], v[176:179], v[64:79]
    ds_read_b128 v[160:163], v16 offset:32768
    ds_read_b64_tr_b16 v[168:169], v19 offset:53248
    s_waitcnt lgkmcnt(4)
    v_mfma_f32_32x32x16_bf16 v[80:95], v[184:187], v[180:183], v[80:95]
    ds_read_b64_tr_b16 v[170:171], v19 offset:53504
    ds_read_b128 v[164:167], v16 offset:36864
    s_waitcnt lgkmcnt(4)
    v_mfma_f32_32x32x16_bf16 v[96:111], v[176:179], v[188:191], v[96:111]
    ds_read_b64_tr_b16 v[172:173], v19 offset:61440
    ds_read_b64_tr_b16 v[174:175], v19 offset:61696
    v_mfma_f32_32x32x16_bf16 v[112:127], v[180:183], v[188:191], v[112:127]
    s_waitcnt lgkmcnt(3)
    v_mfma_f32_32x32x16_bf16 v[64:79], v[168:171], v[160:163], v[64:79]
    ds_read_b128 v[176:179], v17 offset:32768
    ds_read_b64_tr_b16 v[184:185], v19 offset:55296
    s_waitcnt lgkmcnt(4)
    v_mfma_f32_32x32x16_bf16 v[80:95], v[168:171], v[164:167], v[80:95]
    ds_read_b64_tr_b16 v[186:187], v19 offset:55552
    ds_read_b128 v[180:183], v17 offset:36864
    s_waitcnt lgkmcnt(4)
    v_mfma_f32_32x32x16_bf16 v[96:111], v[160:163], v[172:175], v[96:111]
    ds_read_b64_tr_b16 v[188:189], v19 offset:63488
    ds_read_b64_tr_b16 v[190:191], v19 offset:63744
    v_mfma_f32_32x32x16_bf16 v[112:127], v[164:167], v[172:175], v[112:127]
    s_waitcnt lgkmcnt(3)
    v_mfma_f32_32x32x16_bf16 v[64:79], v[184:187], v[176:179], v[64:79]
    s_waitcnt lgkmcnt(2)
    v_mfma_f32_32x32x16_bf16 v[80:95], v[184:187], v[180:183], v[80:95]
    s_waitcnt lgkmcnt(0)
    v_mfma_f32_32x32x16_bf16 v[96:111], v[176:179], v[188:191], v[96:111]
    v_mfma_f32_32x32x16_bf16 v[112:127], v[180:183], v[188:191], v[112:127]
    s_waitcnt vmcnt(0)
    v_cmp_le_u32 vcc, 1, v62
    s_nop 1
    s_cmp_eq_u64 vcc, exec
    s_cbranch_scc0 L_m1p_slow
L_m1p_back:
    v_cmp_eq_u32 vcc, s101, v62
    s_nop 1
    s_cmp_eq_u64 vcc, exec
    s_cselect_b32 s18, 1, 0
    s_cbranch_scc0 L_stslow
    v_cvt_pk_bf16_f32 v64, v64, v65
    v_cvt_pk_bf16_f32 v65, v66, v67
    v_cvt_pk_bf16_f32 v66, v68, v69
    v_cvt_pk_bf16_f32 v67, v70, v71
    v_cvt_pk_bf16_f32 v68, v72, v73
    v_cvt_pk_bf16_f32 v69, v74, v75
    v_cvt_pk_bf16_f32 v70, v76, v77
    v_cvt_pk_bf16_f32 v71, v78, v79
    buffer_store_dwordx4 v[64:67], v2, s[28:31], s97 offen offset:0
    buffer_store_dwordx4 v[68:71], v6, s[28:31], s97 offen offset:0
    v_cvt_pk_bf16_f32 v80, v80, v81
    v_cvt_pk_bf16_f32 v81, v82, v83
    v_cvt_pk_bf16_f32 v82, v84, v85
    v_cvt_pk_bf16_f32 v83, v86, v87
    v_cvt_pk_bf16_f32 v84, v88, v89
    v_cvt_pk_bf16_f32 v85, v90, v91
    v_cvt_pk_bf16_f32 v86, v92, v93
    v_cvt_pk_bf16_f32 v87, v94, v95
    buffer_store_dwordx4 v[80:83], v2, s[28:31], s97 offen offset:1024
    buffer_store_dwordx4 v[84:87], v6, s[28:31], s97 offen offset:1024
    v_cvt_pk_bf16_f32 v96, v96, v97
    v_cvt_pk_bf16_f32 v97, v98, v99
    v_cvt_pk_bf16_f32 v98, v100, v101
    v_cvt_pk_bf16_f32 v99, v102, v103
    v_cvt_pk_bf16_f32 v100, v104, v105
    v_cvt_pk_bf16_f32 v101, v106, v107
    v_cvt_pk_bf16_f32 v102, v108, v109
    v_cvt_pk_bf16_f32 v103, v110, v111
    buffer_store_dwordx4 v[96:99], v7, s[28:31], s98 offen offset:0
    buffer_store_dwordx4 v[100:103], v7, s[28:31], s98 offen offset:512
    v_cvt_pk_bf16_f32 v112, v112, v113
    v_cvt_pk_bf16_f32 v113, v114, v115
    v_cvt_pk_bf16_f32 v114, v116, v117
    v_cvt_pk_bf16_f32 v115, v118, v119
    v_cvt_pk_bf16_f32 v116, v120, v121
    v_cvt_pk_bf16_f32 v117, v122, v123
    v_cvt_pk_bf16_f32 v118, v124, v125
    v_cvt_pk_bf16_f32 v119, v126, v127
    buffer_store_dwordx4 v[112:115], v7, s[28:31], s98 offen offset:1024
    buffer_store_dwordx4 v[116:119], v7, s[28:31], s98 offen offset:1536
    s_waitcnt vmcnt(0) lgkmcnt(0)
    s_branch L_p1done
L_stslow:
    s_nop 7
    s_nop 3
    v_cvt_pk_bf16_f32 v64, v64, v65
    v_cvt_pk_bf16_f32 v65, v66, v67
    v_cvt_pk_bf16_f32 v66, v68, v69
    v_cvt_pk_bf16_f32 v67, v70, v71
    v_cvt_pk_bf16_f32 v68, v72, v73
    v_cvt_pk_bf16_f32 v69, v74, v75
    v_cvt_pk_bf16_f32 v70, v76, v77
    v_cvt_pk_bf16_f32 v71, v78, v79
    buffer_store_dwordx4 v[64:67], v2, s[28:31], s97 offen offset:0 sc1
    buffer_store_dwordx4 v[68:71], v6, s[28:31], s97 offen offset:0 sc1
    v_cvt_pk_bf16_f32 v80, v80, v81
    v_cvt_pk_bf16_f32 v81, v82, v83
    v_cvt_pk_bf16_f32 v82, v84, v85
    v_cvt_pk_bf16_f32 v83, v86, v87
    v_cvt_pk_bf16_f32 v84, v88, v89
    v_cvt_pk_bf16_f32 v85, v90, v91
    v_cvt_pk_bf16_f32 v86, v92, v93
    v_cvt_pk_bf16_f32 v87, v94, v95
    buffer_store_dwordx4 v[80:83], v2, s[28:31], s97 offen offset:1024 sc1
    buffer_store_dwordx4 v[84:87], v6, s[28:31], s97 offen offset:1024 sc1
    v_cvt_pk_bf16_f32 v96, v96, v97
    v_cvt_pk_bf16_f32 v97, v98, v99
    v_cvt_pk_bf16_f32 v98, v100, v101
    v_cvt_pk_bf16_f32 v99, v102, v103
    v_cvt_pk_bf16_f32 v100, v104, v105
    v_cvt_pk_bf16_f32 v101, v106, v107
    v_cvt_pk_bf16_f32 v102, v108, v109
    v_cvt_pk_bf16_f32 v103, v110, v111
    buffer_store_dwordx4 v[96:99], v7, s[28:31], s98 offen offset:0 sc1
    buffer_store_dwordx4 v[100:103], v7, s[28:31], s98 offen offset:512 sc1
    v_cvt_pk_bf16_f32 v112, v112, v113
    v_cvt_pk_bf16_f32 v113, v114, v115
    v_cvt_pk_bf16_f32 v114, v116, v117
    v_cvt_pk_bf16_f32 v115, v118, v119
    v_cvt_pk_bf16_f32 v116, v120, v121
    v_cvt_pk_bf16_f32 v117, v122, v123
    v_cvt_pk_bf16_f32 v118, v124, v125
    v_cvt_pk_bf16_f32 v119, v126, v127
    buffer_store_dwordx4 v[112:115], v7, s[28:31], s98 offen offset:1024 sc1
    buffer_store_dwordx4 v[116:119], v7, s[28:31], s98 offen offset:1536 sc1
    s_waitcnt vmcnt(0) lgkmcnt(0)
    s_branch L_p1done
L_cz:
    buffer_load_dwordx4 v[252:255], v62, s[40:43], s96 offen
    s_cmp_ge_u32 s57, 1
    s_cselect_b32 s36, s18, s16
    s_cselect_b32 s37, s19, s17
    s_mov_b32 s38, 0x80000
    s_mov_b32 s39, 0x20000
    s_lshl_b32 s60, s49, 15
    s_lshl_b32 s61, s51, 11
    s_add_u32 s60, s60, s61
    s_lshl_b32 s61, s58, 10
    s_add_u32 s60, s60, s61
    buffer_load_dwordx4 v[252:255], v2, s[36:39], s60 offen
    s_lshl_b32 s59, s54, 12
    v_add_u32 v10, s59, v20
    v_add_u32 v14, 65536, v10
    v_add_u32 v24, 65536, v20
    v_add_u32 v11, s59, v21
    v_add_u32 v15, 65536, v11
    v_add_u32 v25, 65536, v21
    v_add_u32 v12, s59, v22
    v_add_u32 v16, 65536, v12
    v_add_u32 v26, 65536, v22
    v_add_u32 v13, s59, v23
    v_add_u32 v17, 65536, v13
    v_add_u32 v27, 65536, v23
    v_add_u32 v19, 65536, v18
    v_lshlrev_b32 v8, 2, v5
    v_mul_u32_u24 v8, v8, v4
    v_mul_u32_u24 v7, 528, v4
    v_lshl_add_u32 v7, v5, 4, v7
    s_lshl_b32 s59, s54, 6
    s_add_u32 s59, s59, 65536
    v_add_u32 v7, s59, v7
    v_add_u32 v6, 65536, v2
    s_lshl_b32 s59, s51, 2
    s_add_u32 s59, s59, s54
    s_lshl_b32 s97, s59, 10
    s_lshl_b32 s60, s49, 18
    s_add_u32 s97, s97, s60
    s_lshl_b32 s98, s59, 6
    s_add_u32 s98, s98, 6356992
    s_mov_b32 s60, 73728
    v_mul_lo_u32 v8, v4, s60
    v_lshlrev_b32 v231, 2, v5
    v_sub_u32 v231, v4, v231
    v_cmp_le_i32 s[64:65], 0, v231
    v_cmp_le_i32 s[66:67], 1, v231
    v_cmp_le_i32 s[68:69], 2, v231
    v_cmp_le_i32 s[70:71], 3, v231
    v_cmp_le_i32 s[72:73], 8, v231
    v_cmp_le_i32 s[74:75], 9, v231
    v_cmp_le_i32 s[76:77], 10, v231
    v_cmp_le_i32 s[78:79], 11, v231
    v_cmp_le_i32 s[80:81], 16, v231
    v_cmp_le_i32 s[82:83], 17, v231
    v_cmp_le_i32 s[84:85], 18, v231
    v_cmp_le_i32 s[86:87], 19, v231
    v_cmp_le_i32 s[88:89], 24, v231
    v_cmp_le_i32 s[90:91], 25, v231
    v_cmp_le_i32 s[92:93], 26, v231
    v_cmp_le_i32 s[94:95], 27, v231
    v_mov_b32 v231, 0xffff
    v_mov_b32 v232, 0xffff0000
    v_cndmask_b32 v236, 0, v231, s[64:65]
    v_cndmask_b32 v52, 0, v232, s[66:67]
    v_cndmask_b32 v237, 0, v231, s[68:69]
    v_cndmask_b32 v53, 0, v232, s[70:71]
    v_cndmask_b32 v238, 0, v231, s[72:73]
    v_cndmask_b32 v54, 0, v232, s[74:75]
    v_cndmask_b32 v239, 0, v231, s[76:77]
    v_cndmask_b32 v55, 0, v232, s[78:79]
    v_cndmask_b32 v240, 0, v231, s[80:81]
    v_cndmask_b32 v56, 0, v232, s[82:83]
    v_cndmask_b32 v241, 0, v231, s[84:85]
    v_cndmask_b32 v57, 0, v232, s[86:87]
    v_cndmask_b32 v242, 0, v231, s[88:89]
    v_cndmask_b32 v58, 0, v232, s[90:91]
    v_cndmask_b32 v243, 0, v231, s[92:93]
    v_cndmask_b32 v59, 0, v232, s[94:95]
    v_or_b32 v236, v236, v52
    v_or_b32 v237, v237, v53
    v_or_b32 v238, v238, v54
    v_or_b32 v239, v239, v55
    v_or_b32 v240, v240, v56
    v_or_b32 v241, v241, v57
    v_or_b32 v242, v242, v58
    v_or_b32 v243, v243, v59
    v_mov_b32 v204, 0xf149f2ca
    v_mov_b32 v205, 0xf149f2ca
    v_mov_b32 v206, 0xf149f2ca
    v_mov_b32 v207, 0xf149f2ca
    v_mov_b32 v208, 0xf149f2ca
    v_mov_b32 v209, 0xf149f2ca
    v_mov_b32 v210, 0xf149f2ca
    v_mov_b32 v211, 0xf149f2ca
    v_mov_b32 v212, 0xf149f2ca
    v_mov_b32 v213, 0xf149f2ca
    v_mov_b32 v214, 0xf149f2ca
    v_mov_b32 v215, 0xf149f2ca
    v_mov_b32 v216, 0xf149f2ca
    v_mov_b32 v217, 0xf149f2ca
    v_mov_b32 v218, 0xf149f2ca
    v_mov_b32 v219, 0xf149f2ca
    s_lshl_b32 s62, s56, 3
    s_add_u32 s62, s62, s48
    s_add_u32 s4, s62, s48
    s_sub_i32 s4, s4, 8
    s_max_i32 s4, s4, 0
    s_lshl_b32 s63, s55, 6
    s_add_u32 s4, s4, s63
    s_lshl_b32 s4, s4, 10
    s_add_u32 s4, s4, 2097152
    s_add_u32 s5, s4, 2097152
    s_lshl_b32 s6, s55, 16
    s_lshl_b32 s63, s48, 13
    s_add_u32 s6, s6, s63
    s_lshl_b32 s63, s56, 6
    s_add_u32 s6, s6, s63
    v_lshrrev_b32 v222, 2, v1
    v_lshlrev_b32 v222, 9, v222
    v_and_b32 v231, 3, v1
    v_lshl_add_u32 v222, v231, 4, v222
    v_lshlrev_b32 v233, 11, v231
    v_bfe_u32 v231, v1, 2, 1
    v_lshl_add_u32 v233, v231, 9, v233
    v_lshrrev_b32 v231, 3, v1
    v_lshl_add_u32 v233, v231, 4, v233
    s_lshr_b32 s63, s48, 2
    s_lshl_b32 s63, s63, 10
    s_lshl_b32 s62, s54, 7
    s_add_u32 s63, s63, s62
    s_add_u32 s63, s63, 106496
    v_add_u32 v233, s63, v233
    s_lshl_b32 s63, s48, 10
    s_add_u32 s63, s63, 106496
    v_add_u32 v234, s63, v2
    s_sub_u32 s16, 8, s48
    s_cmp_ge_u32 s56, 1
    s_cselect_b32 s16, 0, s16
    s_lshl_b32 s62, s48, 11
    s_add_u32 s62, s62, 131072
    v_add_u32 v220, s62, v2
    s_lshl_b32 s62, s48, 10
    s_add_u32 s62, s62, 131072
    v_add_u32 v223, s62, v2
    v_and_b32 v224, 15, v1
    v_lshlrev_b32 v224, 4, v224
    v_lshl_add_u32 v224, v5, 8, v224
    v_add_u32 v224, s62, v224
    v_add_u32 v224, 16384, v224
    v_mov_b32 v231, 86016
    v_cmp_gt_u32 vcc, 16, v4
    s_nop 1
    v_cndmask_b32 v224, v231, v224, vcc
    v_mul_u32_u24 v246, 272, v4
    v_lshl_add_u32 v246, v5, 7, v246
    s_lshl_b32 s62, s48, 4
    s_add_u32 s62, s62, 98304
    v_add_u32 v246, s62, v246
    v_lshrrev_b32 v247, 4, v1
    v_mul_u32_u24 v247, 272, v247
    v_and_b32 v231, 15, v1
    v_lshl_add_u32 v247, v231, 4, v247
    s_mul_i32 s62, s48, 1088
    s_add_u32 s62, s62, 98304
    v_add_u32 v247, s62, v247
    v_lshrrev_b32 v248, 4, v1
    v_lshlrev_b32 v248, 16, v248
    v_bfe_u32 v231, v1, 3, 1
    v_lshl_add_u32 v248, v231, 9, v248
    v_and_b32 v231, 7, v1
    v_lshl_add_u32 v248, v231, 4, v248
    s_lshl_b32 s17, s55, 11
    s_lshr_b32 s62, s56, 2
    s_lshl_b32 s62, s62, 10
    s_add_u32 s17, s17, s62
    s_and_b32 s62, s56, 3
    s_lshl_b32 s62, s62, 7
    s_add_u32 s17, s17, s62
    s_lshl_b32 s62, s48, 18
    s_add_u32 s17, s17, s62
    s_add_u32 s17, s17, 10485760
    v_mov_b32 v226, 0x3f803f80
    v_mov_b32 v227, 0x3f803f80
    v_mov_b32 v228, 0x3f803f80
    v_mov_b32 v229, 0x3f803f80
    v_min_u32 v225, 17, v1
    v_lshlrev_b32 v225, 9, v225
    v_add_u32 v225, 86016, v225
    s_lshl_b32 s62, s56, 1
    s_sub_i32 s62, s62, 2
    v_add_u32 v230, s62, v1
    v_max_i32 v230, 0, v230
    v_and_b32 v231, 15, v1
    v_add_u32 v231, 128, v231
    v_cmp_gt_u32 vcc, 4, v1
    s_nop 1
    v_cndmask_b32 v230, v231, v230, vcc
    s_lshl_b32 s62, s49, 4
    v_add_u32 v230, s62, v230
    v_lshlrev_b32 v230, 7, v230
    s_lshl_b32 s62, s56, 1
    s_sub_u32 s63, 14, s62
    s_cmp_ge_u32 s56, 4
    s_cselect_b32 s7, s63, s62
    v_lshrrev_b32 v221, 4, v1
    v_min_u32 v221, 2, v221
    v_add_u32 v221, s7, v221
    v_and_b32 v221, 7, v221
    v_and_b32 v231, 15, v1
    v_lshl_add_u32 v221, v221, 4, v231
    v_add_u32 v221, 256, v221
    v_lshlrev_b32 v221, 7, v221
    s_mov_b32 s19, 13631488
    s_barrier
    ds_read_b128 v[160:163], v10 offset:0
    ds_read_b128 v[164:167], v20 offset:16384
    ds_read_b128 v[168:171], v20 offset:20480
    ds_read_b64_tr_b16 v[172:173], v18 offset:24576
    ds_read_b64_tr_b16 v[174:175], v18 offset:24832
    ds_read_b64_tr_b16 v[176:177], v18 offset:25088
    ds_read_b64_tr_b16 v[178:179], v18 offset:25344
    s_waitcnt lgkmcnt(5)
    v_mfma_f32_32x32x16_bf16 v[64:79], v[160:163], v[164:167], 0
    ds_read_b128 v[180:183], v11 offset:0
    ds_read_b128 v[184:187], v21 offset:16384
    ds_read_b128 v[188:191], v21 offset:20480
    v_lshlrev_b32 v57, 2, v5
    s_waitcnt lgkmcnt(7)
    v_mfma_f32_32x32x16_bf16 v[80:95], v[160:163], v[168:171], 0
    ds_read_b64_tr_b16 v[192:193], v18 offset:26624
    ds_read_b64_tr_b16 v[194:195], v18 offset:26880
    ds_read_b64_tr_b16 v[196:197], v18 offset:27136
    v_mul_u32_u24 v57, v57, v4
    s_waitcnt lgkmcnt(8)
    v_mfma_f32_32x32x16_bf16 v[96:111], v[172:175], v[160:163], 0
    ds_read_b64_tr_b16 v[198:199], v18 offset:27392
    v_mad_u32_u24 v56, v4, 0, v57
    s_waitcnt lgkmcnt(7)
    v_mfma_f32_32x32x16_bf16 v[112:127], v[176:179], v[160:163], 0
    v_and_b32 v56, 31, v56
    v_cvt_f32_u32 v56, v56
    s_waitcnt lgkmcnt(5)
    v_mfma_f32_32x32x16_bf16 v[64:79], v[180:183], v[184:187], v[64:79]
    ds_read_b128 v[160:163], v12 offset:0
    ds_read_b128 v[164:167], v22 offset:16384
    ds_read_b128 v[168:171], v22 offset:20480
    v_mul_f32 v56, 0x3d000000, v56
    s_waitcnt lgkmcnt(7)
    v_mfma_f32_32x32x16_bf16 v[80:95], v[180:183], v[188:191], v[80:95]
    ds_read_b64_tr_b16 v[172:173], v18 offset:28672
    ds_read_b64_tr_b16 v[174:175], v18 offset:28928
    ds_read_b64_tr_b16 v[176:177], v18 offset:29184
    v_cos_f32 v52, v56
    s_waitcnt lgkmcnt(8)
    v_mfma_f32_32x32x16_bf16 v[96:111], v[192:195], v[180:183], v[96:111]
    ds_read_b64_tr_b16 v[178:179], v18 offset:29440
    v_sin_f32 v54, v56
    s_waitcnt lgkmcnt(7)
    v_mfma_f32_32x32x16_bf16 v[112:127], v[196:199], v[180:183], v[112:127]
    s_cmp_lg_u32 s48, 1
    s_cbranch_scc1 L_m2_nodz
    buffer_load_dword v62, v60, s[32:35], 0 offen sc0 sc1
L_m2_nodz:
    s_waitcnt lgkmcnt(5)
    v_mfma_f32_32x32x16_bf16 v[64:79], v[160:163], v[164:167], v[64:79]
    ds_read_b128 v[180:183], v13 offset:0
    ds_read_b128 v[184:187], v23 offset:16384
    ds_read_b128 v[188:191], v23 offset:20480
    v_mad_u32_u24 v56, v4, 1, v57
    s_waitcnt lgkmcnt(7)
    v_mfma_f32_32x32x16_bf16 v[80:95], v[160:163], v[168:171], v[80:95]
    ds_read_b64_tr_b16 v[192:193], v18 offset:30720
    ds_read_b64_tr_b16 v[194:195], v18 offset:30976
    ds_read_b64_tr_b16 v[196:197], v18 offset:31232
    v_and_b32 v56, 31, v56
    s_waitcnt lgkmcnt(8)
    v_mfma_f32_32x32x16_bf16 v[96:111], v[172:175], v[160:163], v[96:111]
    ds_read_b64_tr_b16 v[198:199], v18 offset:31488
    v_cvt_f32_u32 v56, v56
    s_waitcnt lgkmcnt(7)
    v_mfma_f32_32x32x16_bf16 v[112:127], v[176:179], v[160:163], v[112:127]
    v_mul_f32 v56, 0x3d000000, v56
    v_cos_f32 v53, v56
    s_waitcnt lgkmcnt(5)
    v_mfma_f32_32x32x16_bf16 v[64:79], v[180:183], v[184:187], v[64:79]
    s_waitcnt lgkmcnt(0)
    s_barrier
    ds_read_b128 v[160:163], v10 offset:32768
    ds_read_b128 v[164:167], v20 offset:49152
    ds_read_b128 v[168:171], v20 offset:53248
    v_mfma_f32_32x32x16_bf16 v[80:95], v[180:183], v[188:191], v[80:95]
    ds_read_b64_tr_b16 v[172:173], v18 offset:57344
    ds_read_b64_tr_b16 v[174:175], v18 offset:57600
    ds_read_b64_tr_b16 v[176:177], v18 offset:57856
    v_sin_f32 v55, v56
    v_mfma_f32_32x32x16_bf16 v[96:111], v[192:195], v[180:183], v[96:111]
    ds_read_b64_tr_b16 v[178:179], v18 offset:58112
    v_cvt_pk_bf16_f32 v28, v52, v53
    v_mfma_f32_32x32x16_bf16 v[112:127], v[196:199], v[180:183], v[112:127]
    v_cvt_pk_bf16_f32 v36, v54, v55
    v_cvt_pk_bf16_f32 v44, -v52, -v53
    s_waitcnt lgkmcnt(5)
    v_mfma_f32_32x32x16_bf16 v[64:79], v[160:163], v[164:167], v[64:79]
    ds_read_b128 v[180:183], v11 offset:32768
    ds_read_b128 v[184:187], v21 offset:49152
    ds_read_b128 v[188:191], v21 offset:53248
    v_mad_u32_u24 v56, v4, 2, v57
    s_waitcnt lgkmcnt(7)
    v_mfma_f32_32x32x16_bf16 v[80:95], v[160:163], v[168:171], v[80:95]
    ds_read_b64_tr_b16 v[192:193], v18 offset:59392
    ds_read_b64_tr_b16 v[194:195], v18 offset:59648
    ds_read_b64_tr_b16 v[196:197], v18 offset:59904
    v_and_b32 v56, 31, v56
    s_waitcnt lgkmcnt(8)
    v_mfma_f32_32x32x16_bf16 v[96:111], v[172:175], v[160:163], v[96:111]
    ds_read_b64_tr_b16 v[198:199], v18 offset:60160
    v_cvt_f32_u32 v56, v56
    s_waitcnt lgkmcnt(7)
    v_mfma_f32_32x32x16_bf16 v[112:127], v[176:179], v[160:163], v[112:127]
    v_mul_f32 v56, 0x3d000000, v56
    v_cos_f32 v52, v56
    s_waitcnt lgkmcnt(5)
    v_mfma_f32_32x32x16_bf16 v[64:79], v[180:183], v[184:187], v[64:79]
    ds_read_b128 v[160:163], v12 offset:32768
    ds_read_b128 v[164:167], v22 offset:49152
    ds_read_b128 v[168:171], v22 offset:53248
    v_sin_f32 v54, v56
    s_waitcnt lgkmcnt(7)
    v_mfma_f32_32x32x16_bf16 v[80:95], v[180:183], v[188:191], v[80:95]
    ds_read_b64_tr_b16 v[172:173], v18 offset:61440
    ds_read_b64_tr_b16 v[174:175], v18 offset:61696
    ds_read_b64_tr_b16 v[176:177], v18 offset:61952
    v_mad_u32_u24 v56, v4, 3, v57
    s_waitcnt lgkmcnt(8)
    v_mfma_f32_32x32x16_bf16 v[96:111], v[192:195], v[180:183], v[96:111]
    ds_read_b64_tr_b16 v[178:179], v18 offset:62208
    v_and_b32 v56, 31, v56
    s_waitcnt lgkmcnt(7)
    v_mfma_f32_32x32x16_bf16 v[112:127], v[196:199], v[180:183], v[112:127]
    v_cvt_f32_u32 v56, v56
    v_mul_f32 v56, 0x3d000000, v56
    s_waitcnt lgkmcnt(5)
    v_mfma_f32_32x32x16_bf16 v[64:79], v[160:163], v[164:167], v[64:79]
    ds_read_b128 v[180:183], v13 offset:32768
    ds_read_b128 v[184:187], v23 offset:49152
    ds_read_b128 v[188:191], v23 offset:53248
    v_cos_f32 v53, v56
    s_waitcnt lgkmcnt(7)
    v_mfma_f32_32x32x16_bf16 v[80:95], v[160:163], v[168:171], v[80:95]
    ds_read_b64_tr_b16 v[192:193], v18 offset:63488
    ds_read_b64_tr_b16 v[194:195], v18 offset:63744
    ds_read_b64_tr_b16 v[196:197], v18 offset:64000
    v_sin_f32 v55, v56
    s_waitcnt lgkmcnt(8)
    v_mfma_f32_32x32x16_bf16 v[96:111], v[172:175], v[160:163], v[96:111]
    ds_read_b64_tr_b16 v[198:199], v18 offset:64256
    v_cvt_pk_bf16_f32 v29, v52, v53
    s_waitcnt lgkmcnt(7)
    v_mfma_f32_32x32x16_bf16 v[112:127], v[176:179], v[160:163], v[112:127]
    v_cvt_pk_bf16_f32 v37, v54, v55
    v_cvt_pk_bf16_f32 v45, -v52, -v53
    s_waitcnt lgkmcnt(5)
    v_mfma_f32_32x32x16_bf16 v[64:79], v[180:183], v[184:187], v[64:79]
    s_waitcnt lgkmcnt(0)
    s_barrier
    ds_read_b128 v[160:163], v14 offset:0
    ds_read_b128 v[164:167], v24 offset:16384
    ds_read_b128 v[168:171], v24 offset:20480
    v_mfma_f32_32x32x16_bf16 v[80:95], v[180:183], v[188:191], v[80:95]
    ds_read_b64_tr_b16 v[172:173], v19 offset:24576
    ds_read_b64_tr_b16 v[174:175], v19 offset:24832
    ds_read_b64_tr_b16 v[176:177], v19 offset:25088
    v_mad_u32_u24 v56, v4, 8, v57
    v_mfma_f32_32x32x16_bf16 v[96:111], v[192:195], v[180:183], v[96:111]
    ds_read_b64_tr_b16 v[178:179], v19 offset:25344
    v_and_b32 v56, 31, v56
    v_mfma_f32_32x32x16_bf16 v[112:127], v[196:199], v[180:183], v[112:127]
    v_cvt_f32_u32 v56, v56
    v_mul_f32 v56, 0x3d000000, v56
    s_waitcnt lgkmcnt(5)
    v_mfma_f32_32x32x16_bf16 v[64:79], v[160:163], v[164:167], v[64:79]
    ds_read_b128 v[180:183], v15 offset:0
    ds_read_b128 v[184:187], v25 offset:16384
    ds_read_b128 v[188:191], v25 offset:20480
    v_cos_f32 v52, v56
    s_waitcnt lgkmcnt(7)
    v_mfma_f32_32x32x16_bf16 v[80:95], v[160:163], v[168:171], v[80:95]
    ds_read_b64_tr_b16 v[192:193], v19 offset:26624
    ds_read_b64_tr_b16 v[194:195], v19 offset:26880
    ds_read_b64_tr_b16 v[196:197], v19 offset:27136
    v_sin_f32 v54, v56
    s_waitcnt lgkmcnt(8)
    v_mfma_f32_32x32x16_bf16 v[96:111], v[172:175], v[160:163], v[96:111]
    ds_read_b64_tr_b16 v[198:199], v19 offset:27392
    v_mad_u32_u24 v56, v4, 9, v57
    s_waitcnt lgkmcnt(7)
    v_mfma_f32_32x32x16_bf16 v[112:127], v[176:179], v[160:163], v[112:127]
    v_and_b32 v56, 31, v56
    v_cvt_f32_u32 v56, v56
    s_waitcnt lgkmcnt(5)
    v_mfma_f32_32x32x16_bf16 v[64:79], v[180:183], v[184:187], v[64:79]
    ds_read_b128 v[160:163], v16 offset:0
    ds_read_b128 v[164:167], v26 offset:16384
    ds_read_b128 v[168:171], v26 offset:20480
    v_mul_f32 v56, 0x3d000000, v56
    s_waitcnt lgkmcnt(7)
    v_mfma_f32_32x32x16_bf16 v[80:95], v[180:183], v[188:191], v[80:95]
    ds_read_b64_tr_b16 v[172:173], v19 offset:28672
    ds_read_b64_tr_b16 v[174:175], v19 offset:28928
    ds_read_b64_tr_b16 v[176:177], v19 offset:29184
    v_cos_f32 v53, v56
    s_waitcnt lgkmcnt(8)
    v_mfma_f32_32x32x16_bf16 v[96:111], v[192:195], v[180:183], v[96:111]
    ds_read_b64_tr_b16 v[178:179], v19 offset:29440
    v_sin_f32 v55, v56
    s_waitcnt lgkmcnt(7)
    v_mfma_f32_32x32x16_bf16 v[112:127], v[196:199], v[180:183], v[112:127]
    s_cmp_lg_u32 s48, 1
    s_cbranch_scc1 L_m2_nopub
    s_waitcnt vmcnt(0)
    v_cmp_le_u32 vcc, 16, v62
    s_nop 1
    s_cmp_eq_u64 vcc, exec
    s_cbranch_scc0 L_m2z_slow
L_m2z_back:
    s_lshl_b32 s59, s50, 2
    v_mov_b32 v62, s59
    v_mov_b32 v63, s101
    s_mov_b64 exec, 1
    buffer_store_dword v63, v62, s[28:31], s99 offen sc0 sc1
    s_mov_b64 exec, -1
L_m2_nopub:
    s_waitcnt lgkmcnt(5)
    v_mfma_f32_32x32x16_bf16 v[64:79], v[160:163], v[164:167], v[64:79]
    ds_read_b128 v[180:183], v17 offset:0
    ds_read_b128 v[184:187], v27 offset:16384
    ds_read_b128 v[188:191], v27 offset:20480
    v_cvt_pk_bf16_f32 v30, v52, v53
    s_waitcnt lgkmcnt(7)
    v_mfma_f32_32x32x16_bf16 v[80:95], v[160:163], v[168:171], v[80:95]
    ds_read_b64_tr_b16 v[192:193], v19 offset:30720
    ds_read_b64_tr_b16 v[194:195], v19 offset:30976
    ds_read_b64_tr_b16 v[196:197], v19 offset:31232
    v_cvt_pk_bf16_f32 v38, v54, v55
    s_waitcnt lgkmcnt(8)
    v_mfma_f32_32x32x16_bf16 v[96:111], v[172:175], v[160:163], v[96:111]
    ds_read_b64_tr_b16 v[198:199], v19 offset:31488
    v_cvt_pk_bf16_f32 v46, -v52, -v53
    s_waitcnt lgkmcnt(7)
    v_mfma_f32_32x32x16_bf16 v[112:127], v[176:179], v[160:163], v[112:127]
    v_mad_u32_u24 v56, v4, 10, v57
    v_and_b32 v56, 31, v56
    s_waitcnt lgkmcnt(5)
    v_mfma_f32_32x32x16_bf16 v[64:79], v[180:183], v[184:187], v[64:79]
    s_waitcnt lgkmcnt(0)
    s_barrier
    ds_read_b128 v[160:163], v14 offset:32768
    ds_read_b128 v[164:167], v24 offset:49152
    ds_read_b128 v[168:171], v24 offset:53248
    v_mfma_f32_32x32x16_bf16 v[80:95], v[180:183], v[188:191], v[80:95]
    ds_read_b64_tr_b16 v[172:173], v19 offset:57344
    ds_read_b64_tr_b16 v[174:175], v19 offset:57600
    ds_read_b64_tr_b16 v[176:177], v19 offset:57856
    v_cvt_f32_u32 v56, v56
    v_mfma_f32_32x32x16_bf16 v[96:111], v[192:195], v[180:183], v[96:111]
    ds_read_b64_tr_b16 v[178:179], v19 offset:58112
    v_mul_f32 v56, 0x3d000000, v56
    v_mfma_f32_32x32x16_bf16 v[112:127], v[196:199], v[180:183], v[112:127]
    v_cos_f32 v52, v56
    v_sin_f32 v54, v56
    s_waitcnt lgkmcnt(5)
    v_mfma_f32_32x32x16_bf16 v[64:79], v[160:163], v[164:167], v[64:79]
    ds_read_b128 v[180:183], v15 offset:32768
    ds_read_b128 v[184:187], v25 offset:49152
    ds_read_b128 v[188:191], v25 offset:53248
    v_mad_u32_u24 v56, v4, 11, v57
    s_waitcnt lgkmcnt(7)
    v_mfma_f32_32x32x16_bf16 v[80:95], v[160:163], v[168:171], v[80:95]
    ds_read_b64_tr_b16 v[192:193], v19 offset:59392
    ds_read_b64_tr_b16 v[194:195], v19 offset:59648
    ds_read_b64_tr_b16 v[196:197], v19 offset:59904
    v_and_b32 v56, 31, v56
    s_waitcnt lgkmcnt(8)
    v_mfma_f32_32x32x16_bf16 v[96:111], v[172:175], v[160:163], v[96:111]
    ds_read_b64_tr_b16 v[198:199], v19 offset:60160
    v_cvt_f32_u32 v56, v56
    s_waitcnt lgkmcnt(7)
    v_mfma_f32_32x32x16_bf16 v[112:127], v[176:179], v[160:163], v[112:127]
    v_mul_f32 v56, 0x3d000000, v56
    v_cos_f32 v53, v56
    s_waitcnt lgkmcnt(5)
    v_mfma_f32_32x32x16_bf16 v[64:79], v[180:183], v[184:187], v[64:79]
    ds_read_b128 v[160:163], v16 offset:32768
    ds_read_b128 v[164:167], v26 offset:49152
    ds_read_b128 v[168:171], v26 offset:53248
    v_sin_f32 v55, v56
    s_waitcnt lgkmcnt(7)
    v_mfma_f32_32x32x16_bf16 v[80:95], v[180:183], v[188:191], v[80:95]
    ds_read_b64_tr_b16 v[172:173], v19 offset:61440
    ds_read_b64_tr_b16 v[174:175], v19 offset:61696
    ds_read_b64_tr_b16 v[176:177], v19 offset:61952
    v_cvt_pk_bf16_f32 v31, v52, v53
    s_waitcnt lgkmcnt(8)
    v_mfma_f32_32x32x16_bf16 v[96:111], v[192:195], v[180:183], v[96:111]
    ds_read_b64_tr_b16 v[178:179], v19 offset:62208
    v_cvt_pk_bf16_f32 v39, v54, v55
    s_waitcnt lgkmcnt(7)
    v_mfma_f32_32x32x16_bf16 v[112:127], v[196:199], v[180:183], v[112:127]
    v_cvt_pk_bf16_f32 v47, -v52, -v53
    v_mad_u32_u24 v56, v4, 16, v57
    s_waitcnt lgkmcnt(5)
    v_mfma_f32_32x32x16_bf16 v[64:79], v[160:163], v[164:167], v[64:79]
    ds_read_b128 v[180:183], v17 offset:32768
    ds_read_b128 v[184:187], v27 offset:49152
    ds_read_b128 v[188:191], v27 offset:53248
    v_and_b32 v56, 31, v56
    s_waitcnt lgkmcnt(7)
    v_mfma_f32_32x32x16_bf16 v[80:95], v[160:163], v[168:171], v[80:95]
    ds_read_b64_tr_b16 v[192:193], v19 offset:63488
    ds_read_b64_tr_b16 v[194:195], v19 offset:63744
    ds_read_b64_tr_b16 v[196:197], v19 offset:64000
    v_cvt_f32_u32 v56, v56
    s_waitcnt lgkmcnt(8)
    v_mfma_f32_32x32x16_bf16 v[96:111], v[172:175], v[160:163], v[96:111]
    ds_read_b64_tr_b16 v[198:199], v19 offset:64256
    v_mul_f32 v56, 0x3d000000, v56
    s_waitcnt lgkmcnt(7)
    v_mfma_f32_32x32x16_bf16 v[112:127], v[176:179], v[160:163], v[112:127]
    v_cos_f32 v52, v56
    v_sin_f32 v54, v56
    s_waitcnt lgkmcnt(5)
    v_mfma_f32_32x32x16_bf16 v[64:79], v[180:183], v[184:187], v[64:79]
    s_waitcnt lgkmcnt(0)
    s_barrier
    ds_read_b128 v[160:163], v10 offset:0
    ds_read_b128 v[164:167], v20 offset:16384
    ds_read_b128 v[168:171], v20 offset:20480
    v_mfma_f32_32x32x16_bf16 v[80:95], v[180:183], v[188:191], v[80:95]
    ds_read_b64_tr_b16 v[172:173], v18 offset:24576
    ds_read_b64_tr_b16 v[174:175], v18 offset:24832
    ds_read_b64_tr_b16 v[176:177], v18 offset:25088
    v_mad_u32_u24 v56, v4, 17, v57
    v_mfma_f32_32x32x16_bf16 v[96:111], v[192:195], v[180:183], v[96:111]
    ds_read_b64_tr_b16 v[178:179], v18 offset:25344
    v_and_b32 v56, 31, v56
    v_mfma_f32_32x32x16_bf16 v[112:127], v[196:199], v[180:183], v[112:127]
    v_cvt_f32_u32 v56, v56
    v_mul_f32 v56, 0x3d000000, v56
    s_waitcnt lgkmcnt(5)
    v_mfma_f32_32x32x16_bf16 v[64:79], v[160:163], v[164:167], v[64:79]
    ds_read_b128 v[180:183], v11 offset:0
    ds_read_b128 v[184:187], v21 offset:16384
    ds_read_b128 v[188:191], v21 offset:20480
    v_cos_f32 v53, v56
    s_waitcnt lgkmcnt(7)
    v_mfma_f32_32x32x16_bf16 v[80:95], v[160:163], v[168:171], v[80:95]
    ds_read_b64_tr_b16 v[192:193], v18 offset:26624
    ds_read_b64_tr_b16 v[194:195], v18 offset:26880
    ds_read_b64_tr_b16 v[196:197], v18 offset:27136
    v_sin_f32 v55, v56
    s_waitcnt lgkmcnt(8)
    v_mfma_f32_32x32x16_bf16 v[96:111], v[172:175], v[160:163], v[96:111]
    ds_read_b64_tr_b16 v[198:199], v18 offset:27392
    v_cvt_pk_bf16_f32 v32, v52, v53
    s_waitcnt lgkmcnt(7)
    v_mfma_f32_32x32x16_bf16 v[112:127], v[176:179], v[160:163], v[112:127]
    v_cvt_pk_bf16_f32 v40, v54, v55
    v_cvt_pk_bf16_f32 v48, -v52, -v53
    s_waitcnt lgkmcnt(5)
    v_mfma_f32_32x32x16_bf16 v[64:79], v[180:183], v[184:187], v[64:79]
    ds_read_b128 v[160:163], v12 offset:0
    ds_read_b128 v[164:167], v22 offset:16384
    ds_read_b128 v[168:171], v22 offset:20480
    v_mad_u32_u24 v56, v4, 18, v57
    s_waitcnt lgkmcnt(7)
    v_mfma_f32_32x32x16_bf16 v[80:95], v[180:183], v[188:191], v[80:95]
    ds_read_b64_tr_b16 v[172:173], v18 offset:28672
    ds_read_b64_tr_b16 v[174:175], v18 offset:28928
    ds_read_b64_tr_b16 v[176:177], v18 offset:29184
    v_and_b32 v56, 31, v56
    s_waitcnt lgkmcnt(8)
    v_mfma_f32_32x32x16_bf16 v[96:111], v[192:195], v[180:183], v[96:111]
    ds_read_b64_tr_b16 v[178:179], v18 offset:29440
    v_cvt_f32_u32 v56, v56
    s_waitcnt lgkmcnt(7)
    v_mfma_f32_32x32x16_bf16 v[112:127], v[196:199], v[180:183], v[112:127]
    v_mul_f32 v56, 0x3d000000, v56
    v_cos_f32 v52, v56
    s_waitcnt lgkmcnt(5)
    v_mfma_f32_32x32x16_bf16 v[64:79], v[160:163], v[164:167], v[64:79]
    ds_read_b128 v[180:183], v13 offset:0
    ds_read_b128 v[184:187], v23 offset:16384
    ds_read_b128 v[188:191], v23 offset:20480
    v_sin_f32 v54, v56
    s_waitcnt lgkmcnt(7)
    v_mfma_f32_32x32x16_bf16 v[80:95], v[160:163], v[168:171], v[80:95]
    ds_read_b64_tr_b16 v[192:193], v18 offset:30720
    ds_read_b64_tr_b16 v[194:195], v18 offset:30976
    ds_read_b64_tr_b16 v[196:197], v18 offset:31232
    v_mad_u32_u24 v56, v4, 19, v57
    s_waitcnt lgkmcnt(8)
    v_mfma_f32_32x32x16_bf16 v[96:111], v[172:175], v[160:163], v[96:111]
    ds_read_b64_tr_b16 v[198:199], v18 offset:31488
    v_and_b32 v56, 31, v56
    s_waitcnt lgkmcnt(7)
    v_mfma_f32_32x32x16_bf16 v[112:127], v[176:179], v[160:163], v[112:127]
    v_cvt_f32_u32 v56, v56
    v_mul_f32 v56, 0x3d000000, v56
    s_waitcnt lgkmcnt(5)
    v_mfma_f32_32x32x16_bf16 v[64:79], v[180:183], v[184:187], v[64:79]
    s_waitcnt lgkmcnt(0)
    s_barrier
    ds_read_b128 v[160:163], v10 offset:32768
    ds_read_b128 v[164:167], v20 offset:49152
    ds_read_b128 v[168:171], v20 offset:53248
    v_mfma_f32_32x32x16_bf16 v[80:95], v[180:183], v[188:191], v[80:95]
    ds_read_b64_tr_b16 v[172:173], v18 offset:57344
    ds_read_b64_tr_b16 v[174:175], v18 offset:57600
    ds_read_b64_tr_b16 v[176:177], v18 offset:57856
    v_cos_f32 v53, v56
    v_mfma_f32_32x32x16_bf16 v[96:111], v[192:195], v[180:183], v[96:111]
    ds_read_b64_tr_b16 v[178:179], v18 offset:58112
    v_sin_f32 v55, v56
    v_mfma_f32_32x32x16_bf16 v[112:127], v[196:199], v[180:183], v[112:127]
    buffer_load_dword v62, v61, s[28:31], s99 offen sc0 sc1
    s_waitcnt lgkmcnt(5)
    v_mfma_f32_32x32x16_bf16 v[64:79], v[160:163], v[164:167], v[64:79]
    ds_read_b128 v[180:183], v11 offset:32768
    ds_read_b128 v[184:187], v21 offset:49152
    ds_read_b128 v[188:191], v21 offset:53248
    v_cvt_pk_bf16_f32 v33, v52, v53
    s_waitcnt lgkmcnt(7)
    v_mfma_f32_32x32x16_bf16 v[80:95], v[160:163], v[168:171], v[80:95]
    ds_read_b64_tr_b16 v[192:193], v18 offset:59392
    ds_read_b64_tr_b16 v[194:195], v18 offset:59648
    ds_read_b64_tr_b16 v[196:197], v18 offset:59904
    v_cvt_pk_bf16_f32 v41, v54, v55
    s_waitcnt lgkmcnt(8)
    v_mfma_f32_32x32x16_bf16 v[96:111], v[172:175], v[160:163], v[96:111]
    ds_read_b64_tr_b16 v[198:199], v18 offset:60160
    v_cvt_pk_bf16_f32 v49, -v52, -v53
    s_waitcnt lgkmcnt(7)
    v_mfma_f32_32x32x16_bf16 v[112:127], v[176:179], v[160:163], v[112:127]
    v_mad_u32_u24 v56, v4, 24, v57
    v_and_b32 v56, 31, v56
    s_waitcnt lgkmcnt(5)
    v_mfma_f32_32x32x16_bf16 v[64:79], v[180:183], v[184:187], v[64:79]
    ds_read_b128 v[160:163], v12 offset:32768
    ds_read_b128 v[164:167], v22 offset:49152
    ds_read_b128 v[168:171], v22 offset:53248
    v_cvt_f32_u32 v56, v56
    s_waitcnt lgkmcnt(7)
    v_mfma_f32_32x32x16_bf16 v[80:95], v[180:183], v[188:191], v[80:95]
    ds_read_b64_tr_b16 v[172:173], v18 offset:61440
    ds_read_b64_tr_b16 v[174:175], v18 offset:61696
    ds_read_b64_tr_b16 v[176:177], v18 offset:61952
    v_mul_f32 v56, 0x3d000000, v56
    s_waitcnt lgkmcnt(8)
    v_mfma_f32_32x32x16_bf16 v[96:111], v[192:195], v[180:183], v[96:111]
    ds_read_b64_tr_b16 v[178:179], v18 offset:62208
    v_cos_f32 v52, v56
    s_waitcnt lgkmcnt(7)
    v_mfma_f32_32x32x16_bf16 v[112:127], v[196:199], v[180:183], v[112:127]
    v_sin_f32 v54, v56
    v_mad_u32_u24 v56, v4, 25, v57
    s_waitcnt lgkmcnt(5)
    v_mfma_f32_32x32x16_bf16 v[64:79], v[160:163], v[164:167], v[64:79]
    ds_read_b128 v[180:183], v13 offset:32768
    ds_read_b128 v[184:187], v23 offset:49152
    ds_read_b128 v[188:191], v23 offset:53248
    v_and_b32 v56, 31, v56
    s_waitcnt lgkmcnt(7)
    v_mfma_f32_32x32x16_bf16 v[80:95], v[160:163], v[168:171], v[80:95]
    ds_read_b64_tr_b16 v[192:193], v18 offset:63488
    ds_read_b64_tr_b16 v[194:195], v18 offset:63744
    ds_read_b64_tr_b16 v[196:197], v18 offset:64000
    v_cvt_f32_u32 v56, v56
    s_waitcnt lgkmcnt(8)
    v_mfma_f32_32x32x16_bf16 v[96:111], v[172:175], v[160:163], v[96:111]
    ds_read_b64_tr_b16 v[198:199], v18 offset:64256
    v_mul_f32 v56, 0x3d000000, v56
    s_waitcnt lgkmcnt(7)
    v_mfma_f32_32x32x16_bf16 v[112:127], v[176:179], v[160:163], v[112:127]
    v_cos_f32 v53, v56
    v_sin_f32 v55, v56
    s_waitcnt lgkmcnt(5)
    v_mfma_f32_32x32x16_bf16 v[64:79], v[180:183], v[184:187], v[64:79]
    s_waitcnt lgkmcnt(0)
    s_barrier
    ds_read_b128 v[160:163], v14 offset:0
    ds_read_b128 v[164:167], v24 offset:16384
    ds_read_b128 v[168:171], v24 offset:20480
    v_mfma_f32_32x32x16_bf16 v[80:95], v[180:183], v[188:191], v[80:95]
    ds_read_b64_tr_b16 v[172:173], v19 offset:24576
    ds_read_b64_tr_b16 v[174:175], v19 offset:24832
    ds_read_b64_tr_b16 v[176:177], v19 offset:25088
    v_cvt_pk_bf16_f32 v34, v52, v53
    v_mfma_f32_32x32x16_bf16 v[96:111], v[192:195], v[180:183], v[96:111]
    ds_read_b64_tr_b16 v[178:179], v19 offset:25344
    v_cvt_pk_bf16_f32 v42, v54, v55
    v_mfma_f32_32x32x16_bf16 v[112:127], v[196:199], v[180:183], v[112:127]
    v_cvt_pk_bf16_f32 v50, -v52, -v53
    v_mad_u32_u24 v56, v4, 26, v57
    s_waitcnt lgkmcnt(5)
    v_mfma_f32_32x32x16_bf16 v[64:79], v[160:163], v[164:167], v[64:79]
    ds_read_b128 v[180:183], v15 offset:0
    ds_read_b128 v[184:187], v25 offset:16384
    ds_read_b128 v[188:191], v25 offset:20480
    v_and_b32 v56, 31, v56
    s_waitcnt lgkmcnt(7)
    v_mfma_f32_32x32x16_bf16 v[80:95], v[160:163], v[168:171], v[80:95]
    ds_read_b64_tr_b16 v[192:193], v19 offset:26624
    ds_read_b64_tr_b16 v[194:195], v19 offset:26880
    ds_read_b64_tr_b16 v[196:197], v19 offset:27136
    v_cvt_f32_u32 v56, v56
    s_waitcnt lgkmcnt(8)
    v_mfma_f32_32x32x16_bf16 v[96:111], v[172:175], v[160:163], v[96:111]
    ds_read_b64_tr_b16 v[198:199], v19 offset:27392
    v_mul_f32 v56, 0x3d000000, v56
    s_waitcnt lgkmcnt(7)
    v_mfma_f32_32x32x16_bf16 v[112:127], v[176:179], v[160:163], v[112:127]
    v_cos_f32 v52, v56
    v_sin_f32 v54, v56
    s_waitcnt lgkmcnt(5)
    v_mfma_f32_32x32x16_bf16 v[64:79], v[180:183], v[184:187], v[64:79]
    ds_read_b128 v[160:163], v16 offset:0
    ds_read_b128 v[164:167], v26 offset:16384
    ds_read_b128 v[168:171], v26 offset:20480
    v_mad_u32_u24 v56, v4, 27, v57
    s_waitcnt lgkmcnt(7)
    v_mfma_f32_32x32x16_bf16 v[80:95], v[180:183], v[188:191], v[80:95]
    ds_read_b64_tr_b16 v[172:173], v19 offset:28672
    ds_read_b64_tr_b16 v[174:175], v19 offset:28928
    ds_read_b64_tr_b16 v[176:177], v19 offset:29184
    v_and_b32 v56, 31, v56
    s_waitcnt lgkmcnt(8)
    v_mfma_f32_32x32x16_bf16 v[96:111], v[192:195], v[180:183], v[96:111]
    ds_read_b64_tr_b16 v[178:179], v19 offset:29440
    v_cvt_f32_u32 v56, v56
    s_waitcnt lgkmcnt(7)
    v_mfma_f32_32x32x16_bf16 v[112:127], v[196:199], v[180:183], v[112:127]
    v_mul_f32 v56, 0x3d000000, v56
    v_cos_f32 v53, v56
    s_waitcnt lgkmcnt(5)
    v_mfma_f32_32x32x16_bf16 v[64:79], v[160:163], v[164:167], v[64:79]
    ds_read_b128 v[180:183], v17 offset:0
    ds_read_b128 v[184:187], v27 offset:16384
    ds_read_b128 v[188:191], v27 offset:20480
    v_sin_f32 v55, v56
    s_waitcnt lgkmcnt(7)
    v_mfma_f32_32x32x16_bf16 v[80:95], v[160:163], v[168:171], v[80:95]
    ds_read_b64_tr_b16 v[192:193], v19 offset:30720
    ds_read_b64_tr_b16 v[194:195], v19 offset:30976
    ds_read_b64_tr_b16 v[196:197], v19 offset:31232
    v_cvt_pk_bf16_f32 v35, v52, v53
    s_waitcnt lgkmcnt(8)
    v_mfma_f32_32x32x16_bf16 v[96:111], v[172:175], v[160:163], v[96:111]
    ds_read_b64_tr_b16 v[198:199], v19 offset:31488
    v_cvt_pk_bf16_f32 v43, v54, v55
    s_waitcnt lgkmcnt(7)
    v_mfma_f32_32x32x16_bf16 v[112:127], v[176:179], v[160:163], v[112:127]
    v_cvt_pk_bf16_f32 v51, -v52, -v53
    s_waitcnt lgkmcnt(5)
    v_mfma_f32_32x32x16_bf16 v[64:79], v[180:183], v[184:187], v[64:79]
    s_waitcnt lgkmcnt(0)
    s_barrier
    ds_read_b128 v[160:163], v14 offset:32768
    ds_read_b128 v[164:167], v24 offset:49152
    ds_read_b128 v[168:171], v24 offset:53248
    v_mfma_f32_32x32x16_bf16 v[80:95], v[180:183], v[188:191], v[80:95]
    ds_read_b64_tr_b16 v[172:173], v19 offset:57344
    ds_read_b64_tr_b16 v[174:175], v19 offset:57600
    ds_read_b64_tr_b16 v[176:177], v19 offset:57856
    v_mfma_f32_32x32x16_bf16 v[96:111], v[192:195], v[180:183], v[96:111]
    ds_read_b64_tr_b16 v[178:179], v19 offset:58112
    v_mfma_f32_32x32x16_bf16 v[112:127], v[196:199], v[180:183], v[112:127]
    s_waitcnt lgkmcnt(5)
    v_mfma_f32_32x32x16_bf16 v[64:79], v[160:163], v[164:167], v[64:79]
    ds_read_b128 v[180:183], v15 offset:32768
    ds_read_b128 v[184:187], v25 offset:49152
    ds_read_b128 v[188:191], v25 offset:53248
    s_waitcnt lgkmcnt(7)
    v_mfma_f32_32x32x16_bf16 v[80:95], v[160:163], v[168:171], v[80:95]
    ds_read_b64_tr_b16 v[192:193], v19 offset:59392
    ds_read_b64_tr_b16 v[194:195], v19 offset:59648
    ds_read_b64_tr_b16 v[196:197], v19 offset:59904
    s_waitcnt lgkmcnt(8)
    v_mfma_f32_32x32x16_bf16 v[96:111], v[172:175], v[160:163], v[96:111]
    ds_read_b64_tr_b16 v[198:199], v19 offset:60160
    s_waitcnt lgkmcnt(7)
    v_mfma_f32_32x32x16_bf16 v[112:127], v[176:179], v[160:163], v[112:127]
    s_waitcnt lgkmcnt(5)
    v_mfma_f32_32x32x16_bf16 v[64:79], v[180:183], v[184:187], v[64:79]
    ds_read_b128 v[160:163], v16 offset:32768
    ds_read_b128 v[164:167], v26 offset:49152
    ds_read_b128 v[168:171], v26 offset:53248
    s_waitcnt lgkmcnt(7)
    v_mfma_f32_32x32x16_bf16 v[80:95], v[180:183], v[188:191], v[80:95]
    ds_read_b64_tr_b16 v[172:173], v19 offset:61440
    ds_read_b64_tr_b16 v[174:175], v19 offset:61696
    ds_read_b64_tr_b16 v[176:177], v19 offset:61952
    s_waitcnt lgkmcnt(8)
    v_mfma_f32_32x32x16_bf16 v[96:111], v[192:195], v[180:183], v[96:111]
    ds_read_b64_tr_b16 v[178:179], v19 offset:62208
    s_waitcnt lgkmcnt(7)
    v_mfma_f32_32x32x16_bf16 v[112:127], v[196:199], v[180:183], v[112:127]
    s_waitcnt lgkmcnt(5)
    v_mfma_f32_32x32x16_bf16 v[64:79], v[160:163], v[164:167], v[64:79]
    ds_read_b128 v[180:183], v17 offset:32768
    ds_read_b128 v[184:187], v27 offset:49152
    ds_read_b128 v[188:191], v27 offset:53248
    s_waitcnt lgkmcnt(7)
    v_mfma_f32_32x32x16_bf16 v[80:95], v[160:163], v[168:171], v[80:95]
    ds_read_b64_tr_b16 v[192:193], v19 offset:63488
    ds_read_b64_tr_b16 v[194:195], v19 offset:63744
    ds_read_b64_tr_b16 v[196:197], v19 offset:64000
    s_waitcnt lgkmcnt(8)
    v_mfma_f32_32x32x16_bf16 v[96:111], v[172:175], v[160:163], v[96:111]
    ds_read_b64_tr_b16 v[198:199], v19 offset:64256
    s_waitcnt lgkmcnt(7)
    v_mfma_f32_32x32x16_bf16 v[112:127], v[176:179], v[160:163], v[112:127]
    s_waitcnt lgkmcnt(5)
    v_mfma_f32_32x32x16_bf16 v[64:79], v[180:183], v[184:187], v[64:79]
    s_waitcnt lgkmcnt(4)
    v_mfma_f32_32x32x16_bf16 v[80:95], v[180:183], v[188:191], v[80:95]
    s_waitcnt lgkmcnt(2)
    v_mfma_f32_32x32x16_bf16 v[96:111], v[192:195], v[180:183], v[96:111]
    s_waitcnt lgkmcnt(0)
    v_mfma_f32_32x32x16_bf16 v[112:127], v[196:199], v[180:183], v[112:127]
    s_waitcnt vmcnt(0)
    v_cmp_le_u32 vcc, 1, v62
    s_nop 1
    s_cmp_eq_u64 vcc, exec
    s_cbranch_scc0 L_m2p_slow
L_m2p_back:
    v_cmp_eq_u32 vcc, s101, v62
    s_nop 1
    s_cmp_eq_u64 vcc, exec
    s_cselect_b32 s18, 1, 0
    v_cvt_pk_bf16_f32 v64, v64, v65
    v_cvt_pk_bf16_f32 v65, v66, v67
    v_cvt_pk_bf16_f32 v66, v68, v69
    v_cvt_pk_bf16_f32 v67, v70, v71
    v_cvt_pk_bf16_f32 v68, v72, v73
    v_cvt_pk_bf16_f32 v69, v74, v75
    v_cvt_pk_bf16_f32 v70, v76, v77
    v_cvt_pk_bf16_f32 v71, v78, v79
    v_cvt_pk_bf16_f32 v80, v80, v81
    v_cvt_pk_bf16_f32 v81, v82, v83
    v_cvt_pk_bf16_f32 v82, v84, v85
    v_cvt_pk_bf16_f32 v83, v86, v87
    v_cvt_pk_bf16_f32 v84, v88, v89
    v_cvt_pk_bf16_f32 v85, v90, v91
    v_cvt_pk_bf16_f32 v86, v92, v93
    v_cvt_pk_bf16_f32 v87, v94, v95
    s_mov_b32 s60, 0x3eb8aa3b
    s_add_u32 s59, s97, 131072
    v_pk_mul_f32 v[96:97], v[96:97], s[60:61] op_sel_hi:[1,0]
    v_pk_mul_f32 v[98:99], v[98:99], s[60:61] op_sel_hi:[1,0]
    v_pk_mul_f32 v[100:101], v[100:101], s[60:61] op_sel_hi:[1,0]
    v_pk_mul_f32 v[102:103], v[102:103], s[60:61] op_sel_hi:[1,0]
    v_pk_mul_f32 v[104:105], v[104:105], s[60:61] op_sel_hi:[1,0]
    v_pk_mul_f32 v[106:107], v[106:107], s[60:61] op_sel_hi:[1,0]
    v_pk_mul_f32 v[108:109], v[108:109], s[60:61] op_sel_hi:[1,0]
    v_pk_mul_f32 v[110:111], v[110:111], s[60:61] op_sel_hi:[1,0]
    v_pk_mul_f32 v[112:113], v[112:113], s[60:61] op_sel_hi:[1,0]
    v_pk_mul_f32 v[114:115], v[114:115], s[60:61] op_sel_hi:[1,0]
    v_pk_mul_f32 v[116:117], v[116:117], s[60:61] op_sel_hi:[1,0]
    v_pk_mul_f32 v[118:119], v[118:119], s[60:61] op_sel_hi:[1,0]
    v_pk_mul_f32 v[120:121], v[120:121], s[60:61] op_sel_hi:[1,0]
    v_pk_mul_f32 v[122:123], v[122:123], s[60:61] op_sel_hi:[1,0]
    v_pk_mul_f32 v[124:125], v[124:125], s[60:61] op_sel_hi:[1,0]
    v_pk_mul_f32 v[126:127], v[126:127], s[60:61] op_sel_hi:[1,0]
    v_cvt_pk_bf16_f32 v96, v96, v97
    v_cvt_pk_bf16_f32 v97, v98, v99
    v_cvt_pk_bf16_f32 v98, v100, v101
    v_cvt_pk_bf16_f32 v99, v102, v103
    v_cvt_pk_bf16_f32 v100, v104, v105
    v_cvt_pk_bf16_f32 v101, v106, v107
    v_cvt_pk_bf16_f32 v102, v108, v109
    v_cvt_pk_bf16_f32 v103, v110, v111
    v_cvt_pk_bf16_f32 v112, v112, v113
    v_cvt_pk_bf16_f32 v113, v114, v115
    v_cvt_pk_bf16_f32 v114, v116, v117
    v_cvt_pk_bf16_f32 v115, v118, v119
    v_cvt_pk_bf16_f32 v116, v120, v121
    v_cvt_pk_bf16_f32 v117, v122, v123
    v_cvt_pk_bf16_f32 v118, v124, v125
    v_cvt_pk_bf16_f32 v119, v126, v127
    s_cmp_eq_u32 s18, 0
    s_cbranch_scc1 L_qslow
    buffer_store_dwordx4 v[96:99], v2, s[28:31], s97 offen
    buffer_store_dwordx4 v[100:103], v6, s[28:31], s97 offen
    buffer_store_dwordx4 v[112:115], v2, s[28:31], s59 offen
    buffer_store_dwordx4 v[116:119], v6, s[28:31], s59 offen
    s_branch L_qdone
L_qslow:
    buffer_store_dwordx4 v[96:99], v2, s[28:31], s97 offen sc1
    buffer_store_dwordx4 v[100:103], v6, s[28:31], s97 offen sc1
    buffer_store_dwordx4 v[112:115], v2, s[28:31], s59 offen sc1
    buffer_store_dwordx4 v[116:119], v6, s[28:31], s59 offen sc1
L_qdone:
    s_cmp_lg_u32 s49, 0
    s_cbranch_scc1 L_nonyq
    v_mfma_f32_32x32x16_bf16 v[128:143], v[80:83], v[28:31], 0
    v_mfma_f32_32x32x16_bf16 v[144:159], v[80:83], v[36:39], 0
    v_mfma_f32_32x32x16_bf16 v[128:143], v[84:87], v[32:35], v[128:143]
    v_mfma_f32_32x32x16_bf16 v[144:159], v[84:87], v[40:43], v[144:159]
    v_cmp_eq_u32 vcc, 0, v4
    s_nop 1
    v_cndmask_b32 v80, v80, v60, vcc
    v_cndmask_b32 v81, v81, v60, vcc
    v_cndmask_b32 v82, v82, v60, vcc
    v_cndmask_b32 v83, v83, v60, vcc
    v_cndmask_b32 v84, v84, v60, vcc
    v_cndmask_b32 v85, v85, v60, vcc
    v_cndmask_b32 v86, v86, v60, vcc
    v_cndmask_b32 v87, v87, v60, vcc
    v_cvt_pk_bf16_f32 v128, v128, v128
    v_cvt_pk_bf16_f32 v144, v144, v144
    s_add_u32 s59, s98, 4096
    s_mov_b32 exec_hi, 0
    buffer_store_short v128, v8, s[28:31], s98 offen sc1
    buffer_store_short v144, v8, s[28:31], s59 offen sc1
    s_mov_b64 exec, -1
    s_nop 3
L_nonyq:
    v_mfma_f32_32x32x16_bf16 v[128:143], v[64:67], v[28:31], 0
    v_mfma_f32_32x32x16_bf16 v[144:159], v[64:67], v[36:39], 0
    v_mfma_f32_32x32x16_bf16 v[128:143], v[68:71], v[32:35], v[128:143]
    v_mfma_f32_32x32x16_bf16 v[144:159], v[68:71], v[40:43], v[144:159]
    v_mfma_f32_32x32x16_bf16 v[128:143], v[80:83], v[36:39], v[128:143]
    v_mfma_f32_32x32x16_bf16 v[144:159], v[80:83], v[44:47], v[144:159]
    v_mfma_f32_32x32x16_bf16 v[128:143], v[84:87], v[40:43], v[128:143]
    v_mfma_f32_32x32x16_bf16 v[144:159], v[84:87], v[48:51], v[144:159]
    s_nop 10
    v_cvt_pk_bf16_f32 v128, v128, v129
    v_cvt_pk_bf16_f32 v129, v130, v131
    v_cvt_pk_bf16_f32 v130, v132, v133
    v_cvt_pk_bf16_f32 v131, v134, v135
    v_cvt_pk_bf16_f32 v132, v136, v137
    v_cvt_pk_bf16_f32 v133, v138, v139
    v_cvt_pk_bf16_f32 v134, v140, v141
    v_cvt_pk_bf16_f32 v135, v142, v143
    v_permlane32_swap_b32 v128, v130
    v_permlane32_swap_b32 v129, v131
    v_permlane32_swap_b32 v132, v134
    v_permlane32_swap_b32 v133, v135
    ds_write_b128 v7, v[128:131] offset:0
    ds_write_b128 v7, v[132:135] offset:32
    v_cvt_pk_bf16_f32 v144, v144, v145
    v_cvt_pk_bf16_f32 v145, v146, v147
    v_cvt_pk_bf16_f32 v146, v148, v149
    v_cvt_pk_bf16_f32 v147, v150, v151
    v_cvt_pk_bf16_f32 v148, v152, v153
    v_cvt_pk_bf16_f32 v149, v154, v155
    v_cvt_pk_bf16_f32 v150, v156, v157
    v_cvt_pk_bf16_f32 v151, v158, v159
    v_permlane32_swap_b32 v144, v146
    v_permlane32_swap_b32 v145, v147
    v_permlane32_swap_b32 v148, v150
    v_permlane32_swap_b32 v149, v151
    ds_write_b128 v7, v[144:147] offset:256
    ds_write_b128 v7, v[148:151] offset:288
    s_waitcnt vmcnt(0) lgkmcnt(0)
L_ustore:
    s_mul_i32 s59, s48, 2112
    s_add_u32 s59, s59, 65536
    v_mul_u32_u24 v20, 528, v5
    v_lshl_add_u32 v20, v4, 4, v20
    v_add_u32 v20, s59, v20
    v_mul_u32_u24 v21, 73728, v5
    v_bfe_u32 v22, v1, 4, 1
    v_lshl_add_u32 v21, v22, 12, v21
    v_and_b32 v22, 15, v1
    v_lshl_add_u32 v21, v22, 4, v21
    s_mul_i32 s59, s48, 294912
    s_lshl_b32 s60, s49, 13
    s_add_u32 s59, s59, s60
    s_lshl_b32 s60, s51, 8
    s_add_u32 s59, s59, s60
    s_add_u32 s59, s59, 6291456
    s_add_u32 s60, s59, 147456
    s_lshl_b32 s61, s49, 4
    s_add_u32 s61, s61, s51
    s_add_u32 s61, s61, 128
    s_lshl_b32 s61, s61, 7
    v_mov_b32 v28, s61
    v_mov_b32 v29, 1
    s_barrier
    ds_read_b128 v[64:67], v20 offset:0
    ds_read_b128 v[68:71], v20 offset:1056
    s_cmp_lg_u32 s48, 0
    s_cbranch_scc1 L_noflq
    s_mov_b64 exec, 1
    s_cmp_eq_u32 s18, 0
    s_cbranch_scc1 L_flq_s
    buffer_store_dword v29, v28, s[28:31], s19 offen
    s_branch L_flq_d
L_flq_s:
    buffer_store_dword v29, v28, s[28:31], s19 offen sc0 sc1
L_flq_d:
    s_mov_b64 exec, -1
L_noflq:
    s_waitcnt lgkmcnt(1)
    buffer_store_dwordx4 v[64:67], v21, s[28:31], s59 offen sc1
    s_waitcnt lgkmcnt(0)
    buffer_store_dwordx4 v[68:71], v21, s[28:31], s60 offen sc1
    s_branch L_p1done
L_p1done:
    s_mul_i32 s59, s53, 256
    s_lshl_b32 s60, s49, 4
    s_add_u32 s59, s59, s60
    s_add_u32 s59, s59, s51
    s_lshl_b32 s59, s59, 7
    v_mov_b32 v8, s59
    v_mov_b32 v9, 1
    s_barrier
    s_cmp_lg_u32 s48, 0
    s_cbranch_scc1 L_s1wait
    s_cmp_eq_u32 s53, 1
    s_cbranch_scc1 L_nofla
    s_mov_b64 exec, 1
    s_cmp_eq_u32 s18, 0
    s_cbranch_scc1 L_fla_s
    buffer_store_dword v9, v8, s[28:31], s19 offen
    s_branch L_fla_d
L_fla_s:
    buffer_store_dword v9, v8, s[28:31], s19 offen sc0 sc1
L_fla_d:
    s_mov_b64 exec, -1
L_nofla:
    s_mov_b32 s3, 0
L_p1:
    buffer_load_dword v3, v230, s[28:31], s19 offen sc0 sc1
    s_waitcnt vmcnt(0)
    v_cmp_le_u32 vcc, 1, v3
    s_nop 1
    s_cmp_eq_u64 vcc, exec
    s_cbranch_scc1 L_p1_ok
    s_sleep 1
    s_add_u32 s3, s3, 1
    s_cmp_lt_u32 s3, 200000
    s_cbranch_scc1 L_p1
L_p1_ok:
    v_mov_b32 v249, 96256
    v_mov_b32 v250, s18
    ds_write_b32 v249, v250 offset:4
L_s1wait:
    ds_write_b128 v225, v[226:229]
    v_mov_b32 v249, 96256
    v_mov_b32 v250, 0
    ds_write_b32 v249, v250
    s_barrier
    buffer_load_dwordx4 v[124:127], v2, s[28:31], s4 offen sc1
    buffer_load_dwordx4 v[128:131], v2, s[28:31], s4 offen offset:1024 sc1
    buffer_load_dwordx4 v[12:15], v222, s[28:31], s6 offen sc1
    buffer_load_dwordx4 v[172:175], v2, s[28:31], s5 offen sc1
    buffer_load_dwordx4 v[176:179], v2, s[28:31], s5 offen offset:1024 sc1
    v_mov_b32 v188, -1
    v_mov_b32 v189, -1
    v_mov_b32 v190, -1
    v_mov_b32 v191, -1
    s_waitcnt vmcnt(4)
    ds_write_b128 v220, v[124:127] offset:0
    s_waitcnt vmcnt(3)
    ds_write_b128 v220, v[128:131] offset:1024
    s_waitcnt vmcnt(2)
    ds_write_b128 v233, v[12:15]
    s_waitcnt lgkmcnt(0)
    s_barrier
    ds_read_b128 v[12:15], v234
    ds_read_b128 v[16:19], v223 offset:0
    ds_read_b128 v[48:51], v223 offset:8192
    ds_read_b128 v[20:23], v223 offset:1024
    ds_read_b128 v[24:27], v223 offset:2048
    ds_read_b128 v[28:31], v223 offset:3072
    ds_read_b128 v[32:35], v223 offset:4096
    ds_read_b128 v[36:39], v223 offset:5120
    ds_read_b128 v[40:43], v223 offset:6144
    ds_read_b128 v[44:47], v223 offset:7168
    s_waitcnt vmcnt(0)
    ds_write_b128 v220, v[172:175] offset:16384
    ds_write_b128 v220, v[176:179] offset:17408
    buffer_store_dwordx4 v[188:191], v248, s[28:31], s17 offen sc1
    s_lshl_b32 s62, s48, 1
    s_add_u32 s62, s62, s53
    s_cmp_lg_u32 s62, 1
    s_cbranch_scc1 L_nofb
    s_mov_b64 exec, 1
    buffer_store_dword v9, v8, s[28:31], s19 offen sc0 sc1
    s_mov_b64 exec, -1
L_nofb:
    s_waitcnt lgkmcnt(10)
    s_cmp_gt_u32 s16, 0
    s_cbranch_scc1 L_alt0
    v_mfma_f32_32x32x16_bf16 v[124:139], v[16:19], v[12:15], 0
L_back0:
    s_waitcnt lgkmcnt(9)
    v_mfma_f32_32x32x16_bf16 v[140:155], v[48:51], v[12:15], 0
    s_waitcnt lgkmcnt(8)
    s_cmp_gt_u32 s16, 1
    s_cbranch_scc1 L_alt1
    v_mfma_f32_32x32x16_bf16 v[156:171], v[20:23], v[12:15], 0
L_back1:
    s_waitcnt lgkmcnt(0)
    s_nop 6
    v_cndmask_b32 v172, v124, v140, s[64:65]
    v_cndmask_b32 v173, v125, v141, s[66:67]
    v_cndmask_b32 v174, v126, v142, s[68:69]
    v_cndmask_b32 v175, v127, v143, s[70:71]
    v_cndmask_b32 v176, v128, v144, s[72:73]
    v_cndmask_b32 v177, v129, v145, s[74:75]
    v_cndmask_b32 v178, v130, v146, s[76:77]
    v_cndmask_b32 v179, v131, v147, s[78:79]
    v_cndmask_b32 v180, v132, v148, s[80:81]
    v_cndmask_b32 v181, v133, v149, s[82:83]
    v_cndmask_b32 v182, v134, v150, s[84:85]
    v_cndmask_b32 v183, v135, v151, s[86:87]
    v_cndmask_b32 v184, v136, v152, s[88:89]
    v_cndmask_b32 v185, v137, v153, s[90:91]
    v_cndmask_b32 v186, v138, v154, s[92:93]
    v_cndmask_b32 v187, v139, v155, s[94:95]
    s_barrier
    s_cmp_gt_u32 s16, 2
    s_cbranch_scc1 L_alt2
    v_mfma_f32_32x32x16_bf16 v[124:139], v[24:27], v[12:15], 0
L_back2:
    s_cmp_gt_u32 s16, 3
    s_cbranch_scc1 L_alt3
    v_mfma_f32_32x32x16_bf16 v[140:155], v[28:31], v[12:15], 0
L_back3:
    v_max3_f32 v244, v172, v173, v174
    v_max_f32 v245, v175, v175
    v_max3_f32 v244, v244, v176, v177
    v_max3_f32 v245, v245, v178, v179
    v_max3_f32 v244, v244, v180, v181
    v_max3_f32 v245, v245, v182, v183
    v_max3_f32 v244, v244, v184, v185
    v_max3_f32 v245, v245, v186, v187
    v_max3_f32 v244, v244, v156, v157
    v_max3_f32 v245, v245, v158, v159
    v_max3_f32 v244, v244, v160, v161
    v_max3_f32 v245, v245, v162, v163
    v_max3_f32 v244, v244, v164, v165
    v_max3_f32 v245, v245, v166, v167
    v_max3_f32 v244, v244, v168, v169
    v_max3_f32 v245, v245, v170, v171
    s_cmp_gt_u32 s16, 4
    s_cbranch_scc1 L_alt4
    v_mfma_f32_32x32x16_bf16 v[156:171], v[32:35], v[12:15], 0
L_back4:
    ds_read_b128 v[52:55], v224 offset:0
    ds_read_b128 v[56:59], v224 offset:512
    ds_read_b128 v[116:119], v224 offset:8192
    v_max3_f32 v244, v244, v124, v125
    v_max3_f32 v245, v245, v126, v127
    v_max3_f32 v244, v244, v128, v129
    v_max3_f32 v245, v245, v130, v131
    v_max3_f32 v244, v244, v132, v133
    v_max3_f32 v245, v245, v134, v135
    v_max3_f32 v244, v244, v136, v137
    v_max3_f32 v245, v245, v138, v139
    s_cmp_gt_u32 s16, 5
    s_cbranch_scc1 L_alt5
    v_mfma_f32_32x32x16_bf16 v[124:139], v[36:39], v[12:15], 0
L_back5:
    ds_read_b128 v[120:123], v224 offset:8704
    ds_read_b128 v[60:63], v224 offset:1024
    ds_read_b128 v[64:67], v224 offset:1536
    v_max3_f32 v244, v244, v140, v141
    v_max3_f32 v245, v245, v142, v143
    v_max3_f32 v244, v244, v144, v145
    v_max3_f32 v245, v245, v146, v147
    v_max3_f32 v244, v244, v148, v149
    v_max3_f32 v245, v245, v150, v151
    v_max3_f32 v244, v244, v152, v153
    v_max3_f32 v245, v245, v154, v155
    s_cmp_gt_u32 s16, 6
    s_cbranch_scc1 L_alt6
    v_mfma_f32_32x32x16_bf16 v[140:155], v[40:43], v[12:15], 0
L_back6:
    ds_read_b128 v[68:71], v224 offset:2048
    ds_read_b128 v[72:75], v224 offset:2560
    ds_read_b128 v[76:79], v224 offset:3072
    v_max3_f32 v244, v244, v156, v157
    v_max3_f32 v245, v245, v158, v159
    v_max3_f32 v244, v244, v160, v161
    v_max3_f32 v245, v245, v162, v163
    v_max3_f32 v244, v244, v164, v165
    v_max3_f32 v245, v245, v166, v167
    v_max3_f32 v244, v244, v168, v169
    v_max3_f32 v245, v245, v170, v171
    s_cmp_gt_u32 s16, 7
    s_cbranch_scc1 L_alt7
    v_mfma_f32_32x32x16_bf16 v[156:171], v[44:47], v[12:15], 0
L_back7:
    ds_read_b128 v[80:83], v224 offset:3584
    ds_read_b128 v[84:87], v224 offset:4096
    ds_read_b128 v[88:91], v224 offset:4608
    v_max3_f32 v244, v244, v124, v125
    v_max3_f32 v245, v245, v126, v127
    v_max3_f32 v244, v244, v128, v129
    v_max3_f32 v245, v245, v130, v131
    v_max3_f32 v244, v244, v132, v133
    v_max3_f32 v245, v245, v134, v135
    v_max3_f32 v244, v244, v136, v137
    v_max3_f32 v245, v245, v138, v139
    ds_read_b128 v[92:95], v224 offset:5120
    ds_read_b128 v[96:99], v224 offset:5632
    ds_read_b128 v[100:103], v224 offset:6144
    v_max3_f32 v244, v244, v140, v141
    v_max3_f32 v245, v245, v142, v143
    v_max3_f32 v244, v244, v144, v145
    v_max3_f32 v245, v245, v146, v147
    v_max3_f32 v244, v244, v148, v149
    v_max3_f32 v245, v245, v150, v151
    v_max3_f32 v244, v244, v152, v153
    v_max3_f32 v245, v245, v154, v155
    ds_read_b128 v[104:107], v224 offset:6656
    ds_read_b128 v[108:111], v224 offset:7168
    ds_read_b128 v[112:115], v224 offset:7680
    v_max3_f32 v244, v244, v156, v157
    v_max3_f32 v245, v245, v158, v159
    v_max3_f32 v244, v244, v160, v161
    v_max3_f32 v245, v245, v162, v163
    v_max3_f32 v244, v244, v164, v165
    v_max3_f32 v245, v245, v166, v167
    v_max3_f32 v244, v244, v168, v169
    v_max3_f32 v245, v245, v170, v171
    v_max_f32 v244, v244, v245
    v_mov_b32 v245, v244
    s_nop 1
    v_permlane32_swap_b32 v244, v245
    v_max_f32 v244, v244, v245
    v_sub_f32 v244, 0, v244
    v_pk_mov_b32 v[188:189], v[244:245], v[244:245] op_sel:[0,0]
    v_pk_mov_b32 v[190:191], v[244:245], v[244:245] op_sel:[0,0]
    v_pk_mov_b32 v[192:193], v[244:245], v[244:245] op_sel:[0,0]
    v_pk_mov_b32 v[194:195], v[244:245], v[244:245] op_sel:[0,0]
    v_pk_mov_b32 v[196:197], v[244:245], v[244:245] op_sel:[0,0]
    v_pk_mov_b32 v[198:199], v[244:245], v[244:245] op_sel:[0,0]
    v_pk_mov_b32 v[200:201], v[244:245], v[244:245] op_sel:[0,0]
    v_pk_mov_b32 v[202:203], v[244:245], v[244:245] op_sel:[0,0]
    s_cmp_lg_u32 s48, 1
    s_cbranch_scc1 L_nou
    s_mov_b32 s3, 0
L_pu:
    buffer_load_dword v3, v221, s[28:31], s19 offen sc0 sc1
    s_waitcnt vmcnt(0)
    v_cmp_le_u32 vcc, 1, v3
    s_nop 1
    s_cmp_eq_u64 vcc, exec
    s_cbranch_scc1 L_pu_ok
    s_sleep 1
    s_add_u32 s3, s3, 1
    s_cmp_lt_u32 s3, 200000
    s_cbranch_scc1 L_pu
L_pu_ok:
    ds_write_b32 v249, v9
L_nou:
    ds_read_b32 v250, v249 offset:4
    s_cmp_gt_u32 s16, 1
    s_cbranch_scc1 L_alt8
    v_mfma_f32_32x32x16_bf16 v[124:139], v[20:23], v[12:15], v[188:203]
L_back8:
    v_pk_add_f32 v[172:173], v[172:173], v[188:189]
    v_pk_add_f32 v[174:175], v[174:175], v[188:189]
    v_pk_add_f32 v[176:177], v[176:177], v[188:189]
    v_pk_add_f32 v[178:179], v[178:179], v[188:189]
    v_pk_add_f32 v[180:181], v[180:181], v[188:189]
    v_pk_add_f32 v[182:183], v[182:183], v[188:189]
    v_pk_add_f32 v[184:185], v[184:185], v[188:189]
    v_pk_add_f32 v[186:187], v[186:187], v[188:189]
    s_cmp_gt_u32 s16, 2
    s_cbranch_scc1 L_alt9
    v_mfma_f32_32x32x16_bf16 v[140:155], v[24:27], v[12:15], v[188:203]
L_back9:
    v_exp_f32 v172, v172
    v_exp_f32 v173, v173
    v_exp_f32 v174, v174
    v_cvt_pk_bf16_f32 v172, v172, v173
    v_exp_f32 v175, v175
    v_exp_f32 v176, v176
    v_cvt_pk_bf16_f32 v173, v174, v175
    v_exp_f32 v177, v177
    s_cmp_gt_u32 s16, 3
    s_cbranch_scc1 L_alt10
    v_mfma_f32_32x32x16_bf16 v[156:171], v[28:31], v[12:15], v[188:203]
L_back10:
    v_exp_f32 v178, v178
    v_cvt_pk_bf16_f32 v174, v176, v177
    v_exp_f32 v179, v179
    v_exp_f32 v180, v180
    v_cvt_pk_bf16_f32 v175, v178, v179
    v_exp_f32 v181, v181
    v_exp_f32 v182, v182
    v_cvt_pk_bf16_f32 v176, v180, v181
    v_exp_f32 v183, v183
    v_exp_f32 v184, v184
    v_cvt_pk_bf16_f32 v177, v182, v183
    v_exp_f32 v185, v185
    v_exp_f32 v186, v186
    v_cvt_pk_bf16_f32 v178, v184, v185
    v_exp_f32 v187, v187
    s_nop 0
    v_cvt_pk_bf16_f32 v179, v186, v187
    v_and_b32 v180, v172, v236
    v_and_b32 v181, v173, v237
    v_and_b32 v182, v174, v238
    v_and_b32 v183, v175, v239
    v_and_b32 v184, v176, v240
    v_and_b32 v185, v177, v241
    v_and_b32 v186, v178, v242
    v_and_b32 v187, v179, v243
    v_bfi_b32 v172, v236, 0, v172
    v_bfi_b32 v173, v237, 0, v173
    v_bfi_b32 v174, v238, 0, v174
    v_bfi_b32 v175, v239, 0, v175
    v_bfi_b32 v176, v240, 0, v176
    v_bfi_b32 v177, v241, 0, v177
    v_bfi_b32 v178, v242, 0, v178
    v_bfi_b32 v179, v243, 0, v179
    s_waitcnt lgkmcnt(0)
    v_readfirstlane_b32 s18, v250
    s_lshl_b32 s62, s50, 3
    s_add_u32 s62, s62, s48
    s_cmp_lg_u32 s62, 3
    s_cbranch_scc1 L_nowb
    buffer_wbl2 sc1
L_nowb:
    s_lshr_b32 s58, s48, 2
    s_bitcmp1_b32 s54, 1
    s_cselect_b32 s44, s14, s12
    s_cselect_b32 s45, s15, s13
    s_mov_b32 s46, 0x800000
    s_mov_b32 s47, 0x20000
    s_lshl_b32 s59, s55, 12
    s_and_b32 s60, s54, 1
    s_lshl_b32 s61, s60, 6
    s_add_u32 s59, s59, s61
    s_lshl_b32 s61, s58, 22
    s_add_u32 s4, s59, s61
    v_lshlrev_b32 v16, 17, v4
    v_lshl_add_u32 v16, v5, 4, v16
    buffer_load_dwordx4 v[24:27], v16, s[44:47], s4 offen offset:0
    buffer_load_dwordx4 v[28:31], v16, s[44:47], s4 offen offset:32
    v_mfma_f32_32x32x16_bf16 v[220:235], v[116:119], v[180:183], 0
    v_exp_f32 v124, v124
    v_exp_f32 v125, v125
    v_exp_f32 v126, v126
    v_cvt_pk_bf16_f32 v124, v124, v125
    v_exp_f32 v127, v127
    v_mfma_f32_32x32x16_bf16 v[220:235], v[120:123], v[184:187], v[220:235]
    v_exp_f32 v128, v128
    v_cvt_pk_bf16_f32 v125, v126, v127
    v_exp_f32 v129, v129
    v_exp_f32 v130, v130
    v_cvt_pk_bf16_f32 v126, v128, v129
    v_mfma_f32_32x32x16_bf16 v[220:235], v[52:55], v[172:175], v[220:235]
    v_exp_f32 v131, v131
    v_exp_f32 v132, v132
    v_cvt_pk_bf16_f32 v127, v130, v131
    v_exp_f32 v133, v133
    v_exp_f32 v134, v134
    v_mfma_f32_32x32x16_bf16 v[220:235], v[56:59], v[176:179], v[220:235]
    v_cvt_pk_bf16_f32 v128, v132, v133
    v_exp_f32 v135, v135
    v_exp_f32 v136, v136
    v_cvt_pk_bf16_f32 v129, v134, v135
    v_exp_f32 v137, v137
    v_exp_f32 v138, v138
    v_cvt_pk_bf16_f32 v130, v136, v137
    v_exp_f32 v139, v139
    s_nop 0
    v_cvt_pk_bf16_f32 v131, v138, v139
    v_mfma_f32_32x32x16_bf16 v[220:235], v[60:63], v[124:127], v[220:235]
    v_exp_f32 v140, v140
    v_exp_f32 v141, v141
    v_exp_f32 v142, v142
    v_cvt_pk_bf16_f32 v140, v140, v141
    v_exp_f32 v143, v143
    v_exp_f32 v144, v144
    v_mfma_f32_32x32x16_bf16 v[220:235], v[64:67], v[128:131], v[220:235]
    v_cvt_pk_bf16_f32 v141, v142, v143
    v_exp_f32 v145, v145
    v_exp_f32 v146, v146
    v_cvt_pk_bf16_f32 v142, v144, v145
    v_exp_f32 v147, v147
    v_exp_f32 v148, v148
    v_cvt_pk_bf16_f32 v143, v146, v147
    s_cmp_gt_u32 s16, 4
    s_cbranch_scc1 L_alt11
    v_mfma_f32_32x32x16_bf16 v[124:139], v[32:35], v[12:15], v[188:203]
L_back11:
    v_exp_f32 v149, v149
    v_exp_f32 v150, v150
    v_cvt_pk_bf16_f32 v144, v148, v149
    v_exp_f32 v151, v151
    v_exp_f32 v152, v152
    v_cvt_pk_bf16_f32 v145, v150, v151
    v_exp_f32 v153, v153
    v_exp_f32 v154, v154
    v_cvt_pk_bf16_f32 v146, v152, v153
    v_exp_f32 v155, v155
    s_nop 0
    v_cvt_pk_bf16_f32 v147, v154, v155
    v_mfma_f32_32x32x16_bf16 v[220:235], v[68:71], v[140:143], v[220:235]
    v_exp_f32 v156, v156
    v_exp_f32 v157, v157
    v_exp_f32 v158, v158
    v_cvt_pk_bf16_f32 v156, v156, v157
    v_exp_f32 v159, v159
    v_exp_f32 v160, v160
    v_mfma_f32_32x32x16_bf16 v[220:235], v[72:75], v[144:147], v[220:235]
    v_cvt_pk_bf16_f32 v157, v158, v159
    v_exp_f32 v161, v161
    v_exp_f32 v162, v162
    v_cvt_pk_bf16_f32 v158, v160, v161
    v_exp_f32 v163, v163
    v_exp_f32 v164, v164
    v_cvt_pk_bf16_f32 v159, v162, v163
    s_cmp_gt_u32 s16, 5
    s_cbranch_scc1 L_alt12
    v_mfma_f32_32x32x16_bf16 v[140:155], v[36:39], v[12:15], v[188:203]
L_back12:
    v_exp_f32 v165, v165
    v_exp_f32 v166, v166
    v_cvt_pk_bf16_f32 v160, v164, v165
    v_exp_f32 v167, v167
    v_exp_f32 v168, v168
    v_cvt_pk_bf16_f32 v161, v166, v167
    v_exp_f32 v169, v169
    v_exp_f32 v170, v170
    v_cvt_pk_bf16_f32 v162, v168, v169
    v_exp_f32 v171, v171
    s_nop 0
    v_cvt_pk_bf16_f32 v163, v170, v171
    v_mfma_f32_32x32x16_bf16 v[220:235], v[76:79], v[156:159], v[220:235]
    v_exp_f32 v124, v124
    v_exp_f32 v125, v125
    v_exp_f32 v126, v126
    v_cvt_pk_bf16_f32 v124, v124, v125
    v_exp_f32 v127, v127
    v_exp_f32 v128, v128
    v_mfma_f32_32x32x16_bf16 v[220:235], v[80:83], v[160:163], v[220:235]
    v_cvt_pk_bf16_f32 v125, v126, v127
    v_exp_f32 v129, v129
    v_exp_f32 v130, v130
    v_cvt_pk_bf16_f32 v126, v128, v129
    v_exp_f32 v131, v131
    v_exp_f32 v132, v132
    v_cvt_pk_bf16_f32 v127, v130, v131
    s_cmp_gt_u32 s16, 6
    s_cbranch_scc1 L_alt13
    v_mfma_f32_32x32x16_bf16 v[156:171], v[40:43], v[12:15], v[188:203]
L_back13:
    v_exp_f32 v133, v133
    v_exp_f32 v134, v134
    v_cvt_pk_bf16_f32 v128, v132, v133
    v_exp_f32 v135, v135
    v_exp_f32 v136, v136
    v_cvt_pk_bf16_f32 v129, v134, v135
    v_exp_f32 v137, v137
    v_exp_f32 v138, v138
    v_cvt_pk_bf16_f32 v130, v136, v137
    v_exp_f32 v139, v139
    s_nop 0
    v_cvt_pk_bf16_f32 v131, v138, v139
    v_mfma_f32_32x32x16_bf16 v[220:235], v[84:87], v[124:127], v[220:235]
    v_exp_f32 v140, v140
    v_exp_f32 v141, v141
    v_exp_f32 v142, v142
    v_cvt_pk_bf16_f32 v140, v140, v141
    v_exp_f32 v143, v143
    v_exp_f32 v144, v144
    v_mfma_f32_32x32x16_bf16 v[220:235], v[88:91], v[128:131], v[220:235]
    v_cvt_pk_bf16_f32 v141, v142, v143
    v_exp_f32 v145, v145
    v_exp_f32 v146, v146
    v_cvt_pk_bf16_f32 v142, v144, v145
    v_exp_f32 v147, v147
    v_exp_f32 v148, v148
    v_cvt_pk_bf16_f32 v143, v146, v147
    s_cmp_gt_u32 s16, 7
    s_cbranch_scc1 L_alt14
    v_mfma_f32_32x32x16_bf16 v[124:139], v[44:47], v[12:15], v[188:203]
L_back14:
    v_exp_f32 v149, v149
    v_exp_f32 v150, v150
    v_cvt_pk_bf16_f32 v144, v148, v149
    v_exp_f32 v151, v151
    v_exp_f32 v152, v152
    v_cvt_pk_bf16_f32 v145, v150, v151
    v_exp_f32 v153, v153
    v_exp_f32 v154, v154
    v_cvt_pk_bf16_f32 v146, v152, v153
    v_exp_f32 v155, v155
    s_nop 0
    v_cvt_pk_bf16_f32 v147, v154, v155
    v_mfma_f32_32x32x16_bf16 v[220:235], v[92:95], v[140:143], v[220:235]
    v_exp_f32 v156, v156
    v_exp_f32 v157, v157
    v_exp_f32 v158, v158
    v_cvt_pk_bf16_f32 v156, v156, v157
    v_exp_f32 v159, v159
    v_exp_f32 v160, v160
    v_cvt_pk_bf16_f32 v157, v158, v159
    v_exp_f32 v161, v161
    v_exp_f32 v162, v162
    v_cvt_pk_bf16_f32 v158, v160, v161
    v_mfma_f32_32x32x16_bf16 v[220:235], v[96:99], v[144:147], v[220:235]
    v_exp_f32 v163, v163
    v_exp_f32 v164, v164
    v_cvt_pk_bf16_f32 v159, v162, v163
    v_exp_f32 v165, v165
    v_exp_f32 v166, v166
    v_cvt_pk_bf16_f32 v160, v164, v165
    v_exp_f32 v167, v167
    v_exp_f32 v168, v168
    v_cvt_pk_bf16_f32 v161, v166, v167
    v_exp_f32 v169, v169
    v_exp_f32 v170, v170
    v_cvt_pk_bf16_f32 v162, v168, v169
    v_exp_f32 v171, v171
    s_nop 0
    v_cvt_pk_bf16_f32 v163, v170, v171
    v_mfma_f32_32x32x16_bf16 v[220:235], v[100:103], v[156:159], v[220:235]
    v_exp_f32 v124, v124
    v_exp_f32 v125, v125
    v_exp_f32 v126, v126
    v_cvt_pk_bf16_f32 v124, v124, v125
    v_exp_f32 v127, v127
    v_exp_f32 v128, v128
    v_cvt_pk_bf16_f32 v125, v126, v127
    v_exp_f32 v129, v129
    v_exp_f32 v130, v130
    v_cvt_pk_bf16_f32 v126, v128, v129
    v_mfma_f32_32x32x16_bf16 v[220:235], v[104:107], v[160:163], v[220:235]
    v_exp_f32 v131, v131
    v_exp_f32 v132, v132
    v_cvt_pk_bf16_f32 v127, v130, v131
    v_exp_f32 v133, v133
    v_exp_f32 v134, v134
    v_cvt_pk_bf16_f32 v128, v132, v133
    v_exp_f32 v135, v135
    v_exp_f32 v136, v136
    v_cvt_pk_bf16_f32 v129, v134, v135
    v_exp_f32 v137, v137
    v_exp_f32 v138, v138
    v_cvt_pk_bf16_f32 v130, v136, v137
    v_exp_f32 v139, v139
    s_nop 0
    v_cvt_pk_bf16_f32 v131, v138, v139
    v_mfma_f32_32x32x16_bf16 v[220:235], v[108:111], v[124:127], v[220:235]
    s_nop 0
    v_mfma_f32_32x32x16_bf16 v[220:235], v[112:115], v[128:131], v[220:235]
    s_nop 11
    v_rcp_f32 v9, v228
    s_nop 0
    v_mul_f32 v220, v220, v9
    v_mul_f32 v221, v221, v9
    v_mul_f32 v222, v222, v9
    v_mul_f32 v223, v223, v9
    v_mul_f32 v224, v224, v9
    v_mul_f32 v225, v225, v9
    v_mul_f32 v226, v226, v9
    v_mul_f32 v227, v227, v9
    v_cvt_pk_bf16_f32 v220, v220, v221
    v_cvt_pk_bf16_f32 v221, v222, v223
    v_cvt_pk_bf16_f32 v222, v224, v225
    v_cvt_pk_bf16_f32 v223, v226, v227
    ds_write_b128 v246, v[220:223]
    s_cmp_ge_u32 s48, 4
    s_cbranch_scc1 L_nous
    ds_read_b32 v250, v249
    v_and_b32 v6, 3, v1
    v_lshl_add_u32 v6, v5, 2, v6
    v_sub_u32 v7, 7, v6
    s_cmp_ge_u32 s56, 4
    s_cselect_b64 vcc, -1, 0
    s_sub_u32 s61, 32, s55
    s_and_b32 s61, s61, 31
    s_cmp_ge_u32 s56, 4
    s_cselect_b32 s61, s61, s55
    v_cndmask_b32 v6, v6, v7, vcc
    s_lshl_b32 s62, s7, 2
    v_add_u32 v6, s62, v6
    v_add_u32 v7, 1, v6
    v_bfe_u32 v8, v1, 2, 3
    v_lshlrev_b32 v8, 6, v8
    v_lshrrev_b32 v9, 2, v6
    v_and_b32 v6, 3, v6
    v_lshl_add_u32 v6, v6, 4, v8
    v_lshl_add_u32 v6, v9, 13, v6
    v_lshrrev_b32 v9, 2, v7
    v_and_b32 v7, 3, v7
    v_lshl_add_u32 v7, v7, 4, v8
    v_lshl_add_u32 v7, v9, 13, v7
    s_mul_i32 s61, s61, 73728
    s_lshl_b32 s62, s48, 11
    s_add_u32 s61, s61, s62
    s_add_u32 s5, s61, 6291456
    v_mov_b32 v172, v6
    v_mov_b32 v173, v7
    s_waitcnt vmcnt(0) lgkmcnt(0)
    v_readfirstlane_b32 s6, v250
    s_nop 0
    s_cmp_eq_u32 s6, 0
    s_cbranch_scc1 L_b12
    buffer_load_dwordx4 v[140:143], v172, s[28:31], s5 offen offset:0 sc1
    buffer_load_dword v144, v173, s[28:31], s5 offen offset:0 sc1
    buffer_load_dwordx4 v[148:151], v172, s[28:31], s5 offen offset:512 sc1
    buffer_load_dword v152, v173, s[28:31], s5 offen offset:512 sc1
    buffer_load_dwordx4 v[156:159], v172, s[28:31], s5 offen offset:1024 sc1
    buffer_load_dword v160, v173, s[28:31], s5 offen offset:1024 sc1
    buffer_load_dwordx4 v[164:167], v172, s[28:31], s5 offen offset:1536 sc1
    buffer_load_dword v168, v173, s[28:31], s5 offen offset:1536 sc1
    s_branch L_b12
L_nous:
    s_waitcnt vmcnt(0) lgkmcnt(0)
L_b12:
    s_barrier
    ds_read_b128 v[220:223], v247
    s_and_b32 s10, s2, 15
    s_lshl_b32 s10, s10, 7
    s_add_u32 s60, s10, 13680640
    v_mov_b32 v16, 0
    v_mov_b32 v17, 1
    s_cmp_lg_u32 s48, 0
    s_cbranch_scc1 L_nosig2
    s_mov_b64 exec, 1
    buffer_atomic_add v17, v16, s[28:31], s60 offen sc1
    s_mov_b64 exec, -1
L_nosig2:
    s_waitcnt lgkmcnt(0)
    buffer_store_dwordx4 v[220:223], v248, s[28:31], s17 offen sc1
    s_cmp_ge_u32 s48, 4
    s_cbranch_scc1 L_ul2
    s_cmp_lg_u32 s6, 0
    s_cbranch_scc1 L_ul2
    buffer_load_dwordx4 v[140:143], v172, s[28:31], s5 offen offset:0 sc1
    buffer_load_dword v144, v173, s[28:31], s5 offen offset:0 sc1
    buffer_load_dwordx4 v[148:151], v172, s[28:31], s5 offen offset:512 sc1
    buffer_load_dword v152, v173, s[28:31], s5 offen offset:512 sc1
    buffer_load_dwordx4 v[156:159], v172, s[28:31], s5 offen offset:1024 sc1
    buffer_load_dword v160, v173, s[28:31], s5 offen offset:1024 sc1
    buffer_load_dwordx4 v[164:167], v172, s[28:31], s5 offen offset:1536 sc1
    buffer_load_dword v168, v173, s[28:31], s5 offen offset:1536 sc1
L_ul2:
    s_and_b32 s60, s54, 1
    v_bfe_u32 v6, v1, 2, 2
    v_lshlrev_b32 v6, 6, v6
    v_bfe_u32 v7, v1, 4, 1
    v_xor_b32 v7, s60, v7
    v_lshl_add_u32 v6, v7, 5, v6
    v_and_b32 v7, 3, v1
    v_lshl_add_u32 v6, v7, 3, v6
    s_lshr_b32 s61, s54, 1
    s_lshl_b32 s61, s61, 9
    v_add_u32 v6, s61, v6
    s_lshl_b32 s61, s54, 12
    s_add_u32 s61, s61, 65536
    v_lshl_add_u32 v20, v5, 10, v6
    v_add_u32 v20, s61, v20
    v_xor_b32 v21, 0x200, v20
    s_lshl_b32 s61, s54, 14
    v_lshl_add_u32 v22, v5, 8, v6
    v_add_u32 v22, s61, v22
    v_xor_b32 v23, 0x200, v22
    s_xor_b32 s61, s48, 1
    s_mul_i32 s61, s61, 6144
    s_add_u32 s61, s61, 81920
    v_add_u32 v9, s61, v2
    s_xor_b32 s61, s48, 2
    s_mul_i32 s61, s61, 6144
    s_add_u32 s61, s61, 83968
    v_add_u32 v10, s61, v2
    s_xor_b32 s61, s48, 3
    s_mul_i32 s61, s61, 6144
    s_add_u32 s61, s61, 86016
    v_add_u32 v11, s61, v2
    s_mul_i32 s61, s48, 6144
    s_add_u32 s61, s61, 81920
    v_add_u32 v12, s61, v2
    s_lshl_b32 s62, s55, 16
    s_lshl_b32 s61, s54, 14
    s_add_u32 s62, s62, s61
    s_lshl_b32 s61, s58, 10
    s_add_u32 s62, s62, s61
    s_add_u32 s62, s62, 10485760
    v_lshlrev_b32 v15, 8, v4
    s_lshl_b32 s63, s55, 3
    s_lshl_b32 s61, s58, 13
    s_add_u32 s63, s63, s61
    s_add_u32 s63, s63, 12582912
    s_mov_b32 s40, s22
    s_mov_b32 s41, s23
    s_mov_b32 s42, 0x200000
    s_mov_b32 s43, 0x20000
    v_lshlrev_b32 v13, 15, v4
    v_lshl_add_u32 v13, v5, 4, v13
    s_lshl_b32 s96, s55, 10
    s_lshl_b32 s61, s58, 20
    s_add_u32 s96, s96, s61
    s_lshl_b32 s61, s56, 7
    s_add_u32 s96, s96, s61
    s_lshl_b32 s61, s54, 5
    s_add_u32 s96, s96, s61
    s_cmp_ge_u32 s48, 4
    s_cbranch_scc1 L_nous2
    s_lshl_b32 s61, s48, 12
    s_add_u32 s61, s61, 65536
    v_add_u32 v7, s61, v2
    v_mov_b32 v8, 0xffff
    s_lshr_b32 s61, s48, 1
    s_mul_i32 s61, s61, 0x80008000
    s_waitcnt vmcnt(0)
    s_cmp_lt_u32 s56, 4
    s_cbranch_scc1 L_udirect
    v_bfi_b32 v144, v8, v144, v143
    v_bfi_b32 v145, v8, v143, v142
    v_bfi_b32 v146, v8, v142, v141
    v_bfi_b32 v147, v8, v141, v140
    v_xor_b32 v140, s61, v144
    v_xor_b32 v141, s61, v145
    v_xor_b32 v142, s61, v146
    v_xor_b32 v143, s61, v147
    v_bfi_b32 v152, v8, v152, v151
    v_bfi_b32 v153, v8, v151, v150
    v_bfi_b32 v154, v8, v150, v149
    v_bfi_b32 v155, v8, v149, v148
    v_xor_b32 v148, s61, v152
    v_xor_b32 v149, s61, v153
    v_xor_b32 v150, s61, v154
    v_xor_b32 v151, s61, v155
    v_bfi_b32 v160, v8, v160, v159
    v_bfi_b32 v161, v8, v159, v158
    v_bfi_b32 v162, v8, v158, v157
    v_bfi_b32 v163, v8, v157, v156
    v_xor_b32 v156, s61, v160
    v_xor_b32 v157, s61, v161
    v_xor_b32 v158, s61, v162
    v_xor_b32 v159, s61, v163
    v_bfi_b32 v168, v8, v168, v167
    v_bfi_b32 v169, v8, v167, v166
    v_bfi_b32 v170, v8, v166, v165
    v_bfi_b32 v171, v8, v165, v164
    v_xor_b32 v164, s61, v168
    v_xor_b32 v165, s61, v169
    v_xor_b32 v166, s61, v170
    v_xor_b32 v167, s61, v171
L_udirect:
    ds_write_b128 v7, v[140:143] offset:0
    ds_write_b128 v7, v[148:151] offset:1024
    ds_write_b128 v7, v[156:159] offset:2048
    ds_write_b128 v7, v[164:167] offset:3072
L_nous2:
    s_mov_b32 s60, 0
    s_cmp_lg_u32 s48, 0
    s_cbranch_scc1 L_s2wait
    v_and_b32 v16, 15, v1
    v_lshlrev_b32 v16, 7, v16
    s_lshl_b32 s10, s49, 7
    s_add_u32 s100, s10, 13682688
    s_mov_b32 s61, 13680640
    v_mov_b32 v8, 0
    s_cmp_eq_u32 s18, 0
    s_cbranch_scc1 L_p2g
    s_cmp_eq_u32 s50, 0
    s_cbranch_scc1 L_p2g
    s_mov_b64 exec, 1
    s_mov_b32 s3, 0
L_p2l:
    buffer_load_dword v3, v8, s[28:31], s100 offen sc1
    s_waitcnt vmcnt(0)
    v_cmp_le_u32 vcc, 1, v3
    s_nop 1
    s_cmp_eq_u64 vcc, exec
    s_cbranch_scc1 L_p2l_ok
    s_sleep 1
    s_add_u32 s3, s3, 1
    s_cmp_lt_u32 s3, 200000
    s_cbranch_scc1 L_p2l
L_p2l_ok:
    s_mov_b64 exec, -1
    s_branch L_s2wait
L_p2g:
    s_mov_b64 exec, 0xffff
    s_mov_b32 s3, 0
L_p2:
    buffer_load_dword v3, v16, s[28:31], s61 offen sc0 sc1
    s_waitcnt vmcnt(0)
    v_cmp_le_u32 vcc, 16, v3
    s_nop 1
    s_cmp_eq_u64 vcc, exec
    s_cbranch_scc1 L_p2_ok
    s_sleep 1
    s_add_u32 s3, s3, 1
    s_cmp_lt_u32 s3, 200000
    s_cbranch_scc1 L_p2
L_p2_ok:
    s_mov_b64 exec, 1
    buffer_store_dword v17, v8, s[28:31], s100 offen
    s_mov_b64 exec, -1
L_s2wait:
    s_waitcnt vmcnt(0) lgkmcnt(0)
    s_barrier
L_p3load:
    s_mov_b32 s59, s62
    buffer_load_dwordx2 v[18:19], v15, s[28:31], s63 offen sc1
    buffer_load_dwordx4 v[32:35], v2, s[28:31], s59 offen offset:0 sc1
    buffer_load_dwordx4 v[36:39], v2, s[28:31], s59 offen offset:2048 sc1
    s_add_u32 s59, s59, 4096
    buffer_load_dwordx4 v[40:43], v2, s[28:31], s59 offen offset:0 sc1
    buffer_load_dwordx4 v[44:47], v2, s[28:31], s59 offen offset:2048 sc1
    s_add_u32 s59, s59, 4096
    buffer_load_dwordx4 v[48:51], v2, s[28:31], s59 offen offset:0 sc1
    buffer_load_dwordx4 v[52:55], v2, s[28:31], s59 offen offset:2048 sc1
    s_add_u32 s59, s59, 4096
    buffer_load_dwordx4 v[56:59], v2, s[28:31], s59 offen offset:0 sc1
    buffer_load_dwordx4 v[60:63], v2, s[28:31], s59 offen offset:2048 sc1
    ds_read_b64_tr_b16 v[128:129], v20 offset:0
    ds_read_b64_tr_b16 v[130:131], v20 offset:256
    ds_read_b64_tr_b16 v[132:133], v21 offset:0
    ds_read_b64_tr_b16 v[134:135], v21 offset:256
    ds_read_b64_tr_b16 v[136:137], v20 offset:2048
    ds_read_b64_tr_b16 v[138:139], v20 offset:2304
    ds_read_b64_tr_b16 v[140:141], v21 offset:2048
    ds_read_b64_tr_b16 v[142:143], v21 offset:2304
    s_waitcnt lgkmcnt(6)
    v_mfma_f32_32x32x16_bf16 v[64:79], v[128:131], v[24:27], 0
    s_waitcnt lgkmcnt(4)
    v_mfma_f32_32x32x16_bf16 v[80:95], v[132:135], v[24:27], 0
    ds_read_b64_tr_b16 v[128:129], v22 offset:0
    ds_read_b64_tr_b16 v[130:131], v22 offset:1024
    ds_read_b64_tr_b16 v[132:133], v23 offset:0
    ds_read_b64_tr_b16 v[134:135], v23 offset:1024
    s_waitcnt lgkmcnt(6)
    v_mfma_f32_32x32x16_bf16 v[64:79], v[136:139], v[28:31], v[64:79]
    s_waitcnt lgkmcnt(4)
    v_mfma_f32_32x32x16_bf16 v[80:95], v[140:143], v[28:31], v[80:95]
    ds_read_b64_tr_b16 v[136:137], v22 offset:2048
    ds_read_b64_tr_b16 v[138:139], v22 offset:3072
    ds_read_b64_tr_b16 v[140:141], v23 offset:2048
    ds_read_b64_tr_b16 v[142:143], v23 offset:3072
    s_waitcnt vmcnt(7)
    s_waitcnt lgkmcnt(6)
    v_mfma_f32_32x32x16_bf16 v[96:111], v[128:131], v[32:35], 0
    s_waitcnt lgkmcnt(4)
    v_mfma_f32_32x32x16_bf16 v[112:127], v[132:135], v[32:35], 0
    ds_read_b64_tr_b16 v[128:129], v22 offset:4096
    ds_read_b64_tr_b16 v[130:131], v22 offset:5120
    ds_read_b64_tr_b16 v[132:133], v23 offset:4096
    ds_read_b64_tr_b16 v[134:135], v23 offset:5120
    v_max3_u32 v16, v32, v33, v34
    v_max_u32 v16, v16, v35
    s_waitcnt vmcnt(6)
    s_waitcnt lgkmcnt(6)
    v_mfma_f32_32x32x16_bf16 v[96:111], v[136:139], v[36:39], v[96:111]
    s_waitcnt lgkmcnt(4)
    v_mfma_f32_32x32x16_bf16 v[112:127], v[140:143], v[36:39], v[112:127]
    ds_read_b64_tr_b16 v[136:137], v22 offset:6144
    ds_read_b64_tr_b16 v[138:139], v22 offset:7168
    ds_read_b64_tr_b16 v[140:141], v23 offset:6144
    ds_read_b64_tr_b16 v[142:143], v23 offset:7168
    v_pk_mul_f32 v[64:65], v[64:65], v[18:19] op_sel:[0,1] op_sel_hi:[1,1]
    v_pk_mul_f32 v[66:67], v[66:67], v[18:19] op_sel:[0,1] op_sel_hi:[1,1]
    v_pk_mul_f32 v[68:69], v[68:69], v[18:19] op_sel:[0,1] op_sel_hi:[1,1]
    v_pk_mul_f32 v[70:71], v[70:71], v[18:19] op_sel:[0,1] op_sel_hi:[1,1]
    v_pk_mul_f32 v[72:73], v[72:73], v[18:19] op_sel:[0,1] op_sel_hi:[1,1]
    v_pk_mul_f32 v[74:75], v[74:75], v[18:19] op_sel:[0,1] op_sel_hi:[1,1]
    v_pk_mul_f32 v[76:77], v[76:77], v[18:19] op_sel:[0,1] op_sel_hi:[1,1]
    v_pk_mul_f32 v[78:79], v[78:79], v[18:19] op_sel:[0,1] op_sel_hi:[1,1]
    v_max3_u32 v16, v16, v36, v37
    v_max3_u32 v16, v16, v38, v39
    s_waitcnt vmcnt(5)
    s_waitcnt lgkmcnt(6)
    v_mfma_f32_32x32x16_bf16 v[96:111], v[128:131], v[40:43], v[96:111]
    s_waitcnt lgkmcnt(4)
    v_mfma_f32_32x32x16_bf16 v[112:127], v[132:135], v[40:43], v[112:127]
    ds_read_b64_tr_b16 v[128:129], v22 offset:8192
    ds_read_b64_tr_b16 v[130:131], v22 offset:9216
    ds_read_b64_tr_b16 v[132:133], v23 offset:8192
    ds_read_b64_tr_b16 v[134:135], v23 offset:9216
    v_pk_mul_f32 v[80:81], v[80:81], v[18:19] op_sel:[0,1] op_sel_hi:[1,1]
    v_pk_mul_f32 v[82:83], v[82:83], v[18:19] op_sel:[0,1] op_sel_hi:[1,1]
    v_pk_mul_f32 v[84:85], v[84:85], v[18:19] op_sel:[0,1] op_sel_hi:[1,1]
    v_pk_mul_f32 v[86:87], v[86:87], v[18:19] op_sel:[0,1] op_sel_hi:[1,1]
    v_pk_mul_f32 v[88:89], v[88:89], v[18:19] op_sel:[0,1] op_sel_hi:[1,1]
    v_pk_mul_f32 v[90:91], v[90:91], v[18:19] op_sel:[0,1] op_sel_hi:[1,1]
    v_pk_mul_f32 v[92:93], v[92:93], v[18:19] op_sel:[0,1] op_sel_hi:[1,1]
    v_pk_mul_f32 v[94:95], v[94:95], v[18:19] op_sel:[0,1] op_sel_hi:[1,1]
    v_max3_u32 v16, v16, v40, v41
    v_max3_u32 v16, v16, v42, v43
    s_waitcnt vmcnt(4)
    s_waitcnt lgkmcnt(6)
    v_mfma_f32_32x32x16_bf16 v[96:111], v[136:139], v[44:47], v[96:111]
    s_waitcnt lgkmcnt(4)
    v_mfma_f32_32x32x16_bf16 v[112:127], v[140:143], v[44:47], v[112:127]
    ds_read_b64_tr_b16 v[136:137], v22 offset:10240
    ds_read_b64_tr_b16 v[138:139], v22 offset:11264
    ds_read_b64_tr_b16 v[140:141], v23 offset:10240
    ds_read_b64_tr_b16 v[142:143], v23 offset:11264
    v_max3_u32 v16, v16, v44, v45
    v_max3_u32 v16, v16, v46, v47
    s_waitcnt vmcnt(3)
    s_waitcnt lgkmcnt(6)
    v_mfma_f32_32x32x16_bf16 v[96:111], v[128:131], v[48:51], v[96:111]
    s_waitcnt lgkmcnt(4)
    v_mfma_f32_32x32x16_bf16 v[112:127], v[132:135], v[48:51], v[112:127]
    ds_read_b64_tr_b16 v[128:129], v22 offset:12288
    ds_read_b64_tr_b16 v[130:131], v22 offset:13312
    ds_read_b64_tr_b16 v[132:133], v23 offset:12288
    ds_read_b64_tr_b16 v[134:135], v23 offset:13312
    v_max3_u32 v16, v16, v48, v49
    v_max3_u32 v16, v16, v50, v51
    s_waitcnt vmcnt(2)
    s_waitcnt lgkmcnt(6)
    v_mfma_f32_32x32x16_bf16 v[96:111], v[136:139], v[52:55], v[96:111]
    s_waitcnt lgkmcnt(4)
    v_mfma_f32_32x32x16_bf16 v[112:127], v[140:143], v[52:55], v[112:127]
    ds_read_b64_tr_b16 v[136:137], v22 offset:14336
    ds_read_b64_tr_b16 v[138:139], v22 offset:15360
    ds_read_b64_tr_b16 v[140:141], v23 offset:14336
    ds_read_b64_tr_b16 v[142:143], v23 offset:15360
    v_max3_u32 v16, v16, v52, v53
    v_max3_u32 v16, v16, v54, v55
    s_waitcnt vmcnt(1)
    s_waitcnt lgkmcnt(6)
    v_mfma_f32_32x32x16_bf16 v[96:111], v[128:131], v[56:59], v[96:111]
    s_waitcnt lgkmcnt(4)
    v_mfma_f32_32x32x16_bf16 v[112:127], v[132:135], v[56:59], v[112:127]
    v_max3_u32 v16, v16, v56, v57
    v_max3_u32 v16, v16, v58, v59
    s_waitcnt vmcnt(0)
    s_waitcnt lgkmcnt(2)
    v_mfma_f32_32x32x16_bf16 v[96:111], v[136:139], v[60:63], v[96:111]
    s_waitcnt lgkmcnt(0)
    v_mfma_f32_32x32x16_bf16 v[112:127], v[140:143], v[60:63], v[112:127]
    v_max3_u32 v16, v16, v60, v61
    v_max3_u32 v16, v16, v62, v63
    v_cmp_eq_u32 vcc, -1, v16
    s_nop 1
    s_cmp_lg_u64 vcc, 0
    s_cbranch_scc1 L_p3retry
L_p3go:
    s_nop 2
    v_pk_fma_f32 v[72:73], v[104:105], v[18:19], v[72:73] op_sel_hi:[1,0,1]
    v_pk_fma_f32 v[74:75], v[106:107], v[18:19], v[74:75] op_sel_hi:[1,0,1]
    v_pk_fma_f32 v[76:77], v[108:109], v[18:19], v[76:77] op_sel_hi:[1,0,1]
    v_pk_fma_f32 v[78:79], v[110:111], v[18:19], v[78:79] op_sel_hi:[1,0,1]
    ds_write_b128 v9, v[72:75] offset:0
    ds_write_b128 v9, v[76:79] offset:1024
    v_pk_fma_f32 v[80:81], v[112:113], v[18:19], v[80:81] op_sel_hi:[1,0,1]
    v_pk_fma_f32 v[82:83], v[114:115], v[18:19], v[82:83] op_sel_hi:[1,0,1]
    v_pk_fma_f32 v[84:85], v[116:117], v[18:19], v[84:85] op_sel_hi:[1,0,1]
    v_pk_fma_f32 v[86:87], v[118:119], v[18:19], v[86:87] op_sel_hi:[1,0,1]
    ds_write_b128 v10, v[80:83] offset:0
    ds_write_b128 v10, v[84:87] offset:1024
    v_pk_fma_f32 v[88:89], v[120:121], v[18:19], v[88:89] op_sel_hi:[1,0,1]
    v_pk_fma_f32 v[90:91], v[122:123], v[18:19], v[90:91] op_sel_hi:[1,0,1]
    v_pk_fma_f32 v[92:93], v[124:125], v[18:19], v[92:93] op_sel_hi:[1,0,1]
    v_pk_fma_f32 v[94:95], v[126:127], v[18:19], v[94:95] op_sel_hi:[1,0,1]
    ds_write_b128 v11, v[88:91] offset:0
    ds_write_b128 v11, v[92:95] offset:1024
    v_pk_fma_f32 v[64:65], v[96:97], v[18:19], v[64:65] op_sel_hi:[1,0,1]
    v_pk_fma_f32 v[66:67], v[98:99], v[18:19], v[66:67] op_sel_hi:[1,0,1]
    v_pk_fma_f32 v[68:69], v[100:101], v[18:19], v[68:69] op_sel_hi:[1,0,1]
    v_pk_fma_f32 v[70:71], v[102:103], v[18:19], v[70:71] op_sel_hi:[1,0,1]
    s_waitcnt lgkmcnt(0)
    s_barrier
    ds_read_b128 v[32:35], v12 offset:0
    ds_read_b128 v[36:39], v12 offset:1024
    ds_read_b128 v[40:43], v12 offset:2048
    ds_read_b128 v[44:47], v12 offset:3072
    ds_read_b128 v[48:51], v12 offset:4096
    ds_read_b128 v[52:55], v12 offset:5120
    s_waitcnt lgkmcnt(4)
    v_pk_add_f32 v[64:65], v[64:65], v[32:33]
    v_pk_add_f32 v[66:67], v[66:67], v[34:35]
    v_pk_add_f32 v[68:69], v[68:69], v[36:37]
    v_pk_add_f32 v[70:71], v[70:71], v[38:39]
    s_waitcnt lgkmcnt(2)
    v_pk_add_f32 v[64:65], v[64:65], v[40:41]
    v_pk_add_f32 v[66:67], v[66:67], v[42:43]
    v_pk_add_f32 v[68:69], v[68:69], v[44:45]
    v_pk_add_f32 v[70:71], v[70:71], v[46:47]
    s_waitcnt lgkmcnt(0)
    v_pk_add_f32 v[64:65], v[64:65], v[48:49]
    v_pk_add_f32 v[66:67], v[66:67], v[50:51]
    v_pk_add_f32 v[68:69], v[68:69], v[52:53]
    v_pk_add_f32 v[70:71], v[70:71], v[54:55]
    v_cvt_pk_bf16_f32 v64, v64, v65
    v_cvt_pk_bf16_f32 v65, v66, v67
    v_cvt_pk_bf16_f32 v66, v68, v69
    v_cvt_pk_bf16_f32 v67, v70, v71
    s_nop 0
    v_permlane32_swap_b32 v64, v66
    v_permlane32_swap_b32 v65, v67
    buffer_store_dwordx4 v[64:67], v13, s[40:43], s96 offen
L_end:
    s_endpgm
L_m1z_slow:
    s_mov_b32 s3, 0
L_m1z_spin:
    s_sleep 1
    buffer_load_dword v62, v60, s[32:35], 0 offen sc0 sc1
    s_waitcnt vmcnt(0)
    v_cmp_le_u32 vcc, 16, v62
    s_nop 1
    s_cmp_eq_u64 vcc, exec
    s_cbranch_scc1 L_m1z_back
    s_add_u32 s3, s3, 1
    s_cmp_lt_u32 s3, 200000
    s_cbranch_scc1 L_m1z_spin
    s_branch L_m1z_back
L_m1p_slow:
    s_mov_b32 s3, 0
L_m1p_spin:
    s_sleep 1
    buffer_load_dword v62, v61, s[28:31], s99 offen sc0 sc1
    s_waitcnt vmcnt(0)
    v_cmp_le_u32 vcc, 1, v62
    s_nop 1
    s_cmp_eq_u64 vcc, exec
    s_cbranch_scc1 L_m1p_back
    s_add_u32 s3, s3, 1
    s_cmp_lt_u32 s3, 200000
    s_cbranch_scc1 L_m1p_spin
    s_branch L_m1p_back
L_m2z_slow:
    s_mov_b32 s3, 0
L_m2z_spin:
    s_sleep 1
    buffer_load_dword v62, v60, s[32:35], 0 offen sc0 sc1
    s_waitcnt vmcnt(0)
    v_cmp_le_u32 vcc, 16, v62
    s_nop 1
    s_cmp_eq_u64 vcc, exec
    s_cbranch_scc1 L_m2z_back
    s_add_u32 s3, s3, 1
    s_cmp_lt_u32 s3, 200000
    s_cbranch_scc1 L_m2z_spin
    s_branch L_m2z_back
L_m2p_slow:
    s_mov_b32 s3, 0
L_m2p_spin:
    s_sleep 1
    buffer_load_dword v62, v61, s[28:31], s99 offen sc0 sc1
    s_waitcnt vmcnt(0)
    v_cmp_le_u32 vcc, 1, v62
    s_nop 1
    s_cmp_eq_u64 vcc, exec
    s_cbranch_scc1 L_m2p_back
    s_add_u32 s3, s3, 1
    s_cmp_lt_u32 s3, 200000
    s_cbranch_scc1 L_m2p_spin
    s_branch L_m2p_back
L_alt0:
    s_nop 1
    v_mfma_f32_32x32x16_bf16 v[124:139], v[16:19], v[12:15], v[204:219]
    s_branch L_back0
L_alt1:
    s_nop 1
    v_mfma_f32_32x32x16_bf16 v[156:171], v[20:23], v[12:15], v[204:219]
    s_branch L_back1
L_alt2:
    s_nop 1
    v_mfma_f32_32x32x16_bf16 v[124:139], v[24:27], v[12:15], v[204:219]
    s_branch L_back2
L_alt3:
    s_nop 1
    v_mfma_f32_32x32x16_bf16 v[140:155], v[28:31], v[12:15], v[204:219]
    s_branch L_back3
L_alt4:
    s_nop 1
    v_mfma_f32_32x32x16_bf16 v[156:171], v[32:35], v[12:15], v[204:219]
    s_branch L_back4
L_alt5:
    s_nop 1
    v_mfma_f32_32x32x16_bf16 v[124:139], v[36:39], v[12:15], v[204:219]
    s_branch L_back5
L_alt6:
    s_nop 1
    v_mfma_f32_32x32x16_bf16 v[140:155], v[40:43], v[12:15], v[204:219]
    s_branch L_back6
L_alt7:
    s_nop 1
    v_mfma_f32_32x32x16_bf16 v[156:171], v[44:47], v[12:15], v[204:219]
    s_branch L_back7
L_alt8:
    s_nop 1
    v_mfma_f32_32x32x16_bf16 v[124:139], v[20:23], v[12:15], v[204:219]
    s_branch L_back8
L_alt9:
    s_nop 1
    v_mfma_f32_32x32x16_bf16 v[140:155], v[24:27], v[12:15], v[204:219]
    s_branch L_back9
L_alt10:
    s_nop 1
    v_mfma_f32_32x32x16_bf16 v[156:171], v[28:31], v[12:15], v[204:219]
    s_branch L_back10
L_alt11:
    s_nop 1
    v_mfma_f32_32x32x16_bf16 v[124:139], v[32:35], v[12:15], v[204:219]
    s_branch L_back11
L_alt12:
    s_nop 1
    v_mfma_f32_32x32x16_bf16 v[140:155], v[36:39], v[12:15], v[204:219]
    s_branch L_back12
L_alt13:
    s_nop 1
    v_mfma_f32_32x32x16_bf16 v[156:171], v[40:43], v[12:15], v[204:219]
    s_branch L_back13
L_alt14:
    s_nop 1
    v_mfma_f32_32x32x16_bf16 v[124:139], v[44:47], v[12:15], v[204:219]
    s_branch L_back14
L_p3retry:
    s_add_u32 s60, s60, 1
    s_cmp_ge_u32 s60, 2000
    s_cbranch_scc1 L_p3go
    s_sleep 2
    s_nop 7
    s_nop 7
    s_branch L_p3load
L_codeend:
.fill 512, 4, 0xbf800000
.section .rodata,"a"
.p2align 6
.amdhsa_kernel gated_mix__sliding_block__spectral_fnet__prompt_kernel
  .amdhsa_next_free_vgpr 256
  .amdhsa_next_free_sgpr 102
  .amdhsa_accum_offset 256
  .amdhsa_group_segment_fixed_size 0
  .amdhsa_kernarg_size 96
  .amdhsa_user_sgpr_count 2
  .amdhsa_user_sgpr_kernarg_segment_ptr 1
  .amdhsa_system_sgpr_workgroup_id_x 1
.end_amdhsa_kernel
```
